```python
import torch

def _softmax(x, axis=-1):
    return torch.softmax(x, dim=axis)
def _gelu(x):
    return torch.nn.functional.gelu(x, approximate="tanh")
def _silu(x):
    return torch.nn.functional.silu(x)
def _sigmoid(x):
    return torch.sigmoid(x)
def _layernorm(x, axis=-1, eps=1e-5):
    m = x.mean(dim=axis, keepdim=True)
    v = x.var(dim=axis, keepdim=True, unbiased=False)
    return (x - m) / torch.sqrt(v + eps)
def _scatter_add(tgt, idx, src, axis=0):
    return tgt.clone().index_add_(axis, idx, src)
def _segment_sum(src, seg, n):
    out = torch.zeros((n,) + src.shape[1:], dtype=src.dtype)
    return out.index_add_(0, seg, src)
def _pad(x, pw):
    flat = tuple(v for pair in reversed(pw) for v in pair)
    return torch.nn.functional.pad(x, flat)

kernel_name = 'concat_heads__ssm_conv_s4__linear_kernel_hedgehog__prompt'

def setup_inputs():

    _w = (lambda a: (lambda t: t.to(torch.bfloat16) if t.is_floating_point() else t)(torch.as_tensor(a)))
    def _A_setup():
        B, L, D, N = 1, 2048, 448, 256
        A_re = -(lambda _x: torch.exp(torch.as_tensor(_x)))((lambda *s: torch.randn(*s, dtype=torch.bfloat16) * 3.2)(D, N))
        A_im = torch.pi * (lambda *s: torch.randn(*s, dtype=torch.bfloat16) * 0.2)(D, N)
        B_re = (lambda *s: torch.randn(*s, dtype=torch.bfloat16) * 0.4)(D, N)
        B_im = (lambda *s: torch.randn(*s, dtype=torch.bfloat16) * 0.4)(D, N)
        C_re = (lambda *s: torch.randn(*s, dtype=torch.bfloat16) * 0.4)(D, N)
        C_im = (lambda *s: torch.randn(*s, dtype=torch.bfloat16) * 0.4)(D, N)
        log_dt = (lambda *s: torch.randn(*s, dtype=torch.bfloat16) * 0.2)(D) * 0.5 - 4.0
        Dskip = (lambda *s: torch.randn(*s, dtype=torch.bfloat16) * 0.4)(D)
        return {
            "u": _w((lambda *s: torch.randn(*s, dtype=torch.bfloat16) * 0.05)(B, L, D)),
            "A_re": _w(A_re),
            "A_im": _w(A_im),
            "B_re": _w(B_re),
            "B_im": _w(B_im),
            "C_re": _w(C_re),
            "C_im": _w(C_im),
            "log_dt": _w(log_dt),
            "Dskip": _w(Dskip),
        }
    _A_in = _A_setup()

    def _B_setup():
        B, S, D, H = 1, 2048, 448, 16
        Dh = D // H
        return {
            "x": _w((lambda *s: torch.randn(*s, dtype=torch.bfloat16) * 0.4)(B, S, D)),
            "wqkv": _w((lambda *s: torch.randn(*s, dtype=torch.bfloat16) * 0.4)(D, 3 * D)),
            "w_phi": _w((lambda *s: torch.randn(*s, dtype=torch.bfloat16) * 0.4)(H, Dh, Dh) * (Dh ** -0.5)),
            "wo": _w((lambda *s: torch.randn(*s, dtype=torch.bfloat16) * 0.05)(D, D)),
        }
    _B_in = _B_setup()

    return {
        "A_u": _A_in["u"],
        "A_A_re": _A_in["A_re"],
        "A_A_im": _A_in["A_im"],
        "A_B_re": _A_in["B_re"],
        "A_B_im": _A_in["B_im"],
        "A_C_re": _A_in["C_re"],
        "A_C_im": _A_in["C_im"],
        "A_log_dt": _A_in["log_dt"],
        "A_Dskip": _A_in["Dskip"],
        "B_x": _B_in["x"],
        "B_wqkv": _B_in["wqkv"],
        "B_w_phi": _B_in["w_phi"],
        "B_wo": _B_in["wo"],
    }

def reference(A_u, A_A_re, A_A_im, A_B_re, A_B_im, A_C_re, A_C_im, A_log_dt, A_Dskip, B_x, B_wqkv, B_w_phi, B_wo):
    def _A_ref(u, A_re, A_im, B_re, B_im, C_re, C_im, log_dt, Dskip):
        Bsz, L, D = u.shape
        dt = torch.exp(log_dt)[:, None]
        A = A_re + 1j * A_im
        Bc = B_re + 1j * B_im
        Cc = C_re + 1j * C_im
        logdA = dt * A
        dB = dt * Bc
        l = (lambda x, dt: x.to(dt))(torch.arange(L), A_re.dtype)
        P = torch.exp(logdA[:, :, None] * l[None, None, :])
        K = torch.einsum("dn,dnl,dn->dl", Cc, P, dB).real
        L2 = 2 * L
        Kp = _pad(K, ((0, 0), (0, L)))
        up = (lambda x, *d: x.permute(*d))(u, 0, 2, 1)
        up = _pad(up, ((0, 0), (0, 0), (0, L)))
        Kf = (lambda x, axes=(-2,-1): torch.fft.rfft2(x.float(), dim=axes))(Kp[:, None, :], axes=(-2, -1))
        Uf = (lambda x, axes=(-2,-1): torch.fft.rfft2(x.float(), dim=axes))(up[:, :, None, :], axes=(-2, -1))
        Yf = Uf * Kf[None, :, :, :]
        y = (lambda x, s, axes=(-2,-1): torch.fft.irfft2(x, s=s, dim=axes).to(torch.bfloat16))(Yf, (1, L2), axes=(-2, -1))[:, :, 0, :L]
        y = (lambda x, *d: x.permute(*d))(y, 0, 2, 1) + u * Dskip[None, None, :]
        return y

    def _B_ref(x, wqkv, w_phi, wo):
        B, S, D = x.shape
        H = 16; Dh = D // H
        qkv = (lambda x, *d: x.permute(*d))((x @ wqkv).reshape(B, S, 3, H, Dh), 2, 0, 3, 1, 4)
        q, k, v = qkv[0], qkv[1], qkv[2]
        pq = torch.einsum("bhsd,hdf->bhsf", q, w_phi)
        pk = torch.einsum("bhsd,hdf->bhsf", k, w_phi)
        phi_q = torch.concatenate([_softmax(pq, axis=-1), _softmax(-pq, axis=-1)], axis=-1)
        phi_k = torch.concatenate([_softmax(pk, axis=-1), _softmax(-pk, axis=-1)], axis=-1)
        kv = torch.einsum("bhsf,bhsd->bhfd", phi_k, v)
        z  = torch.einsum("bhsf->bhf", phi_k)
        num = torch.einsum("bhqf,bhfd->bhqd", phi_q, kv)
        den = torch.einsum("bhqf,bhf->bhq", phi_q, z)[..., None] + 1e-6
        o = num / den
        return (lambda x, *d: x.permute(*d))(o, 0, 2, 1, 3).reshape(B, S, D) @ wo

    a = _A_ref(A_u, A_A_re, A_A_im, A_B_re, A_B_im, A_C_re, A_C_im, A_log_dt, A_Dskip)
    b = _B_ref(B_x, B_wqkv, B_w_phi, B_wo)
    return torch.concatenate([a, b], axis=-1)
```

```asm
; @launch grid=(480,1,1) block=(256,1,1) lds=81920
.amdgcn_target "amdgcn-amd-amdhsa--gfx950"
.text
.globl concat_heads__ssm_conv_s4__linear_kernel_hedgehog__prompt_kernel
.p2align 8
.type concat_heads__ssm_conv_s4__linear_kernel_hedgehog__prompt_kernel,@function
concat_heads__ssm_conv_s4__linear_kernel_hedgehog__prompt_kernel:
  s_cmp_ge_u32 s2, 480
  s_cbranch_scc1 L_exit
  s_cmp_lt_u32 s2, 224
  s_cbranch_scc1 L_A
  s_sub_u32 s2, s2, 224
L_B:
  s_setprio 0
  s_load_dwordx4 s[4:7], s[0:1], 72
  s_load_dwordx4 s[40:43], s[0:1], 88
  s_load_dwordx2 s[44:45], s[0:1], 104
  s_load_dwordx2 s[46:47], s[0:1], 120
  v_lshrrev_b32 v10, 6, v0
  v_and_b32 v0, 63, v0
  s_nop 0
  v_readfirstlane_b32 s33, v10
  s_and_b32 s38, s2, 7
  s_lshl_b32 s38, s38, 2
  s_lshr_b32 s39, s2, 3
  s_and_b32 s39, s39, 3
  s_add_u32 s36, s38, s39
  s_lshr_b32 s37, s2, 5
  s_lshr_b32 s34, s33, 1
  s_and_b32 s35, s33, 1
  s_lshl_b32 s48, s33, 11
  s_mul_i32 s49, s37, 112
  s_mul_i32 s38, s36, 1
  s_mul_i32 s39, s37, 0
  s_add_u32 s38, s38, s39
  s_mul_i32 s39, s38, 9363
  s_lshr_b32 s39, s39, 16
  s_mul_i32 s39, s39, 7
  s_sub_u32 s50, s38, s39
  s_add_u32 s38, s50, 1
  s_cmp_ge_u32 s38, 7
  s_cselect_b32 s51, 0, s38
  s_add_u32 s38, s51, 1
  s_cmp_ge_u32 s38, 7
  s_cselect_b32 s52, 0, s38
  s_add_u32 s38, s52, 1
  s_cmp_ge_u32 s38, 7
  s_cselect_b32 s53, 0, s38
  s_add_u32 s38, s53, 1
  s_cmp_ge_u32 s38, 7
  s_cselect_b32 s54, 0, s38
  s_add_u32 s38, s54, 1
  s_cmp_ge_u32 s38, 7
  s_cselect_b32 s55, 0, s38
  s_add_u32 s38, s55, 1
  s_cmp_ge_u32 s38, 7
  s_cselect_b32 s56, 0, s38
  s_mov_b32 s58, 0
  s_mov_b32 s59, -1
  s_mov_b32 s60, -1
  s_mov_b32 s61, 0
  s_mov_b32 s62, 1069066811
  s_mov_b32 s63, 1069066811
  v_lshlrev_b32 v9, 4, v0
  v_lshrrev_b32 v10, 3, v0
  v_lshrrev_b32 v11, 4, v0
  v_and_b32 v12, 7, v0
  s_lshl_b32 s38, s33, 4
  v_add_u32 v13, s38, v10
  v_xor_b32 v14, v12, v11
  v_lshlrev_b32 v14, 4, v14
  v_mul_u32_u24 v1, 896, v13
  v_add_u32 v1, v1, v14
  v_add_u32 v14, 4, v11
  v_xor_b32 v14, v12, v14
  v_lshlrev_b32 v14, 4, v14
  v_add_u32 v15, 8, v13
  v_mul_u32_u24 v2, 896, v15
  v_add_u32 v2, v2, v14
  v_and_b32 v14, 1, v11
  v_lshlrev_b32 v14, 2, v14
  v_xor_b32 v14, v12, v14
  v_lshrrev_b32 v15, 2, v14
  v_sub_u32 v14, v14, v15
  v_lshlrev_b32 v14, 4, v14
  v_mul_u32_u24 v3, 2688, v13
  v_add_u32 v3, v3, v14
  s_waitcnt lgkmcnt(0)
  s_mul_i32 s38, s36, 57344
  s_add_u32 s4, s4, s38
  s_addc_u32 s5, s5, 0
  s_mov_b32 s8, s4
  s_and_b32 s9, s5, 0xffff
  s_mov_b32 s10, 57344
  s_mov_b32 s11, 0x20000
  s_mov_b32 s12, s6
  s_and_b32 s13, s7, 0xffff
  s_mov_b32 s14, 1204224
  s_mov_b32 s15, 0x20000
  s_mov_b32 s16, s42
  s_and_b32 s17, s43, 0xffff
  s_mov_b32 s18, 401408
  s_mov_b32 s19, 0x20000
  s_mov_b32 s24, s46
  s_and_b32 s25, s47, 0xffff
  s_mov_b32 s26, 12582912
  s_mov_b32 s27, 0x20000
  s_mov_b32 s28, s44
  s_and_b32 s29, s45, 0xffff
  s_mov_b32 s30, 3670016
  s_mov_b32 s31, 0x20000
  s_lshl_b32 s38, s37, 1
  s_add_u32 s38, s38, s35
  s_mul_i32 s38, s38, 1568
  s_add_u32 s40, s40, s38
  s_addc_u32 s41, s41, 0
  s_sub_u32 s39, 25088, s38
  s_mov_b32 s20, s40
  s_and_b32 s21, s41, 0xffff
  s_mov_b32 s22, s39
  s_mov_b32 s23, 0x20000
  s_load_dword s32, s[46:47], 0
  s_lshl_b32 s38, s37, 5
  s_add_u32 s38, s38, s36
  s_mul_i32 s64, s38, 8448
  s_add_u32 s64, s64, 1048576
  s_lshl_b32 s66, s37, 13
  s_add_u32 s66, s66, 5308416
  s_lshl_b32 s38, s36, 1
  s_add_u32 s38, s38, s34
  s_lshl_b32 s38, s38, 4
  s_lshl_b32 s39, s37, 1
  s_add_u32 s38, s38, s39
  s_add_u32 s38, s38, s35
  s_lshl_b32 s65, s38, 11
  s_add_u32 s65, s65, 3211264
  s_add_u32 m0, s48, 0
  s_lshl_b32 s38, s50, 7
  buffer_load_dwordx4 v1, s[8:11], s38 offen lds
  s_add_u32 m0, s48, 1024
  s_lshl_b32 s38, s50, 7
  buffer_load_dwordx4 v2, s[8:11], s38 offen lds
  s_add_u32 m0, s48, 8192
  s_mul_i32 s38, s50, 172032
  s_add_u32 s38, s38, s49
  s_add_u32 s38, s38, 896
  buffer_load_dwordx4 v3, s[12:15], s38 offen lds
  s_add_u32 m0, s48, 9216
  s_mul_i32 s38, s50, 172032
  s_add_u32 s38, s38, s49
  s_add_u32 s38, s38, 22400
  buffer_load_dwordx4 v3, s[12:15], s38 offen lds
  s_add_u32 m0, s48, 16384
  s_lshl_b32 s38, s51, 7
  buffer_load_dwordx4 v1, s[8:11], s38 offen lds
  s_add_u32 m0, s48, 17408
  s_lshl_b32 s38, s51, 7
  buffer_load_dwordx4 v2, s[8:11], s38 offen lds
  s_add_u32 m0, s48, 24576
  s_mul_i32 s38, s51, 172032
  s_add_u32 s38, s38, s49
  s_add_u32 s38, s38, 896
  buffer_load_dwordx4 v3, s[12:15], s38 offen lds
  s_add_u32 m0, s48, 25600
  s_mul_i32 s38, s51, 172032
  s_add_u32 s38, s38, s49
  s_add_u32 s38, s38, 22400
  buffer_load_dwordx4 v3, s[12:15], s38 offen lds
  s_lshl_b32 s38, s35, 12
  s_lshl_b32 s39, s34, 11
  s_add_u32 s38, s38, s39
  s_add_u32 s64, s64, s38
  v_and_b32 v10, 31, v0
  v_lshrrev_b32 v11, 5, v0
  v_lshrrev_b32 v12, 1, v10
  v_and_b32 v12, 7, v12
  s_lshl_b32 s38, s34, 5
  v_add_u32 v13, s38, v10
  v_lshlrev_b32 v13, 7, v13
  v_add_u32 v14, 0, v11
  v_xor_b32 v14, v14, v12
  v_lshlrev_b32 v14, 4, v14
  v_add_u32 v4, v13, v14
  v_add_u32 v14, 2, v11
  v_xor_b32 v14, v14, v12
  v_lshlrev_b32 v14, 4, v14
  v_add_u32 v5, v13, v14
  v_add_u32 v14, 4, v11
  v_xor_b32 v14, v14, v12
  v_lshlrev_b32 v14, 4, v14
  v_add_u32 v6, v13, v14
  v_add_u32 v14, 6, v11
  v_xor_b32 v14, v14, v12
  v_lshlrev_b32 v14, 4, v14
  v_add_u32 v7, v13, v14
  v_lshrrev_b32 v10, 4, v0
  v_and_b32 v10, 1, v10
  v_bfe_u32 v12, v0, 2, 2
  v_and_b32 v13, 3, v0
  v_and_b32 v14, v13, v10
  v_lshrrev_b32 v15, 1, v13
  v_and_b32 v14, v14, v15
  v_sub_u32 v120, v13, v14
  v_lshlrev_b32 v14, 3, v11
  v_add_u32 v14, v14, v12
  v_lshlrev_b32 v8, 7, v14
  v_lshrrev_b32 v14, 1, v12
  v_xor_b32 v14, s35, v14
  v_lshlrev_b32 v14, 6, v14
  v_add_u32 v8, v8, v14
  s_lshl_b32 s38, s35, 3
  v_lshlrev_b32 v14, 5, v10
  v_add_u32 v8, s38, v8
  v_add_u32 v8, v8, v14
  v_lshlrev_b32 v14, 3, v120
  v_add_u32 v8, v8, v14
  v_lshlrev_b32 v14, 2, v11
  v_add_u32 v14, v14, v12
  v_mul_u32_u24 v121, 56, v14
  v_lshlrev_b32 v14, 5, v10
  v_add_u32 v121, v121, v14
  v_lshlrev_b32 v14, 3, v13
  v_add_u32 v121, v121, v14
  v_add_u32 v121, s48, v121
  s_mul_i32 s38, s35, 8704
  s_add_u32 s38, s38, 57344
  v_and_b32 v14, 31, v0
  s_lshl_b32 s39, s34, 5
  v_add_u32 v14, s39, v14
  v_mul_u32_u24 v122, 136, v14
  v_lshlrev_b32 v14, 3, v11
  v_add_u32 v122, v122, v14
  v_add_u32 v122, s38, v122
  v_lshlrev_b32 v14, 2, v11
  v_add_u32 v14, v14, v12
  v_mul_u32_u24 v123, 136, v14
  v_lshlrev_b32 v14, 5, v10
  v_add_u32 v123, v123, v14
  v_lshlrev_b32 v14, 3, v13
  v_add_u32 v123, v123, v14
  s_lshl_b32 s39, s34, 6
  s_add_u32 s38, s38, s39
  v_add_u32 v123, s38, v123
  v_mov_b32 v240, v121
  v_mov_b32 v241, v122
  v_mov_b32 v242, v123
  v_mov_b32 v15, 0
  v_mov_b32 v84, 0
  v_mov_b32 v100, 0
  v_mov_b32 v85, 0
  v_mov_b32 v101, 0
  v_mov_b32 v86, 0
  v_mov_b32 v102, 0
  v_mov_b32 v87, 0
  v_mov_b32 v103, 0
  v_and_b32 v10, 31, v0
  v_lshrrev_b32 v11, 2, v10
  v_and_b32 v12, 3, v10
  v_lshlrev_b32 v12, 3, v12
  v_add_u32 v11, v11, v12
  s_lshl_b32 s38, s37, 5
  v_add_u32 v11, s38, v11
  v_and_b32 v12, 7, v0
  v_lshlrev_b32 v12, 5, v12
  s_and_b32 s38, s2, 31
  v_add_u32 v12, s38, v12
  v_cndmask_b32 v11, v11, v12, s[58:59]
  v_subrev_u32 v12, 224, v11
  v_cmp_gt_u32 vcc, 224, v11
  s_nop 1
  v_cndmask_b32 v11, v12, v11, vcc
  v_lshlrev_b32 v243, 7, v11
  v_lshrrev_b32 v10, 4, v0
  v_mul_u32_u24 v10, 8448, v10
  v_and_b32 v11, 15, v0
  v_lshlrev_b32 v12, 4, v11
  v_add_u32 v247, v10, v12
  v_and_b32 v12, 1, v11
  v_lshlrev_b32 v12, 4, v12
  v_mov_b32 v13, 0x3f80
  v_lshlrev_b32 v12, v12, v13
  v_lshrrev_b32 v11, 1, v11
  v_cmp_eq_u32 vcc, 0, v11
  s_nop 1
  v_cndmask_b32 v248, v15, v12, vcc
  v_cmp_eq_u32 vcc, 1, v11
  s_nop 1
  v_cndmask_b32 v249, v15, v12, vcc
  v_cmp_eq_u32 vcc, 2, v11
  s_nop 1
  v_cndmask_b32 v250, v15, v12, vcc
  v_cmp_eq_u32 vcc, 3, v11
  s_nop 1
  v_cndmask_b32 v251, v15, v12, vcc
  s_add_u32 m0, s48, 32768
  s_lshl_b32 s38, s52, 7
  buffer_load_dwordx4 v1, s[8:11], s38 offen lds
  s_add_u32 m0, s48, 33792
  s_lshl_b32 s38, s52, 7
  buffer_load_dwordx4 v2, s[8:11], s38 offen lds
  s_add_u32 m0, s48, 40960
  s_mul_i32 s38, s52, 172032
  s_add_u32 s38, s38, s49
  s_add_u32 s38, s38, 896
  buffer_load_dwordx4 v3, s[12:15], s38 offen lds
  s_add_u32 m0, s48, 41984
  s_mul_i32 s38, s52, 172032
  s_add_u32 s38, s38, s49
  s_add_u32 s38, s38, 22400
  buffer_load_dwordx4 v3, s[12:15], s38 offen lds
  s_add_u32 m0, s48, 49152
  s_lshl_b32 s38, s53, 7
  buffer_load_dwordx4 v1, s[8:11], s38 offen lds
  s_add_u32 m0, s48, 50176
  s_lshl_b32 s38, s53, 7
  buffer_load_dwordx4 v2, s[8:11], s38 offen lds
  s_add_u32 m0, s48, 57344
  s_mov_b32 s38, 0
  buffer_load_dwordx4 v9, s[20:23], s38 offen lds
  s_add_u32 m0, s48, 58368
  s_mov_b32 s38, 1024
  buffer_load_dwordx4 v9, s[20:23], s38 offen lds
  s_waitcnt vmcnt(12)
  s_barrier
  ds_read_b128 v[128:131], v4 offset:0
  ds_read_b128 v[132:135], v5 offset:0
  ds_read_b128 v[136:139], v6 offset:0
  ds_read_b128 v[140:143], v7 offset:0
  ds_read_b64_tr_b16 v[48:49], v8 offset:8192
  ds_read_b64_tr_b16 v[50:51], v8 offset:8704
  ds_read_b64_tr_b16 v[52:53], v8 offset:10240
  ds_read_b64_tr_b16 v[54:55], v8 offset:10752
  ds_read_b64_tr_b16 v[56:57], v8 offset:12288
  ds_read_b64_tr_b16 v[58:59], v8 offset:12800
  ds_read_b64_tr_b16 v[60:61], v8 offset:14336
  ds_read_b64_tr_b16 v[62:63], v8 offset:14848
  s_waitcnt lgkmcnt(6)
  v_mfma_f32_32x32x16_bf16 v[16:31], v[48:51], v[128:131], 0
  s_waitcnt lgkmcnt(4)
  v_mfma_f32_32x32x16_bf16 v[16:31], v[52:55], v[132:135], v[16:31]
  s_waitcnt lgkmcnt(2)
  v_mfma_f32_32x32x16_bf16 v[16:31], v[56:59], v[136:139], v[16:31]
  s_waitcnt lgkmcnt(0)
  v_mfma_f32_32x32x16_bf16 v[16:31], v[60:63], v[140:143], v[16:31]
  s_waitcnt vmcnt(8)
  s_barrier
  s_add_u32 m0, s48, 0
  s_mul_i32 s38, s53, 172032
  s_add_u32 s38, s38, s49
  s_add_u32 s38, s38, 896
  buffer_load_dwordx4 v3, s[12:15], s38 offen lds
  s_add_u32 m0, s48, 1024
  s_mul_i32 s38, s53, 172032
  s_add_u32 s38, s38, s49
  s_add_u32 s38, s38, 22400
  buffer_load_dwordx4 v3, s[12:15], s38 offen lds
  s_add_u32 m0, s48, 8192
  s_lshl_b32 s38, s54, 7
  buffer_load_dwordx4 v1, s[8:11], s38 offen lds
  s_add_u32 m0, s48, 9216
  s_lshl_b32 s38, s54, 7
  buffer_load_dwordx4 v2, s[8:11], s38 offen lds
  ds_read_b128 v[144:147], v4 offset:16384
  ds_read_b128 v[148:151], v5 offset:16384
  ds_read_b128 v[152:155], v6 offset:16384
  ds_read_b128 v[156:159], v7 offset:16384
  ds_read_b64_tr_b16 v[48:49], v8 offset:24576
  ds_read_b64_tr_b16 v[50:51], v8 offset:25088
  ds_read_b64_tr_b16 v[52:53], v8 offset:26624
  ds_read_b64_tr_b16 v[54:55], v8 offset:27136
  ds_read_b64_tr_b16 v[56:57], v8 offset:28672
  ds_read_b64_tr_b16 v[58:59], v8 offset:29184
  ds_read_b64_tr_b16 v[60:61], v8 offset:30720
  ds_read_b64_tr_b16 v[62:63], v8 offset:31232
  s_waitcnt lgkmcnt(6)
  v_mfma_f32_32x32x16_bf16 v[16:31], v[48:51], v[144:147], v[16:31]
  s_waitcnt lgkmcnt(4)
  v_mfma_f32_32x32x16_bf16 v[16:31], v[52:55], v[148:151], v[16:31]
  s_waitcnt lgkmcnt(2)
  v_mfma_f32_32x32x16_bf16 v[16:31], v[56:59], v[152:155], v[16:31]
  s_waitcnt lgkmcnt(0)
  v_mfma_f32_32x32x16_bf16 v[16:31], v[60:63], v[156:159], v[16:31]
  s_waitcnt vmcnt(8)
  s_barrier
  s_add_u32 m0, s48, 16384
  s_mul_i32 s38, s54, 172032
  s_add_u32 s38, s38, s49
  s_add_u32 s38, s38, 896
  buffer_load_dwordx4 v3, s[12:15], s38 offen lds
  s_add_u32 m0, s48, 17408
  s_mul_i32 s38, s54, 172032
  s_add_u32 s38, s38, s49
  s_add_u32 s38, s38, 22400
  buffer_load_dwordx4 v3, s[12:15], s38 offen lds
  s_add_u32 m0, s48, 24576
  s_lshl_b32 s38, s55, 7
  buffer_load_dwordx4 v1, s[8:11], s38 offen lds
  s_add_u32 m0, s48, 25600
  s_lshl_b32 s38, s55, 7
  buffer_load_dwordx4 v2, s[8:11], s38 offen lds
  ds_read_b128 v[160:163], v4 offset:32768
  ds_read_b128 v[164:167], v5 offset:32768
  ds_read_b128 v[168:171], v6 offset:32768
  ds_read_b128 v[172:175], v7 offset:32768
  ds_read_b64_tr_b16 v[48:49], v8 offset:40960
  ds_read_b64_tr_b16 v[50:51], v8 offset:41472
  ds_read_b64_tr_b16 v[52:53], v8 offset:43008
  ds_read_b64_tr_b16 v[54:55], v8 offset:43520
  ds_read_b64_tr_b16 v[56:57], v8 offset:45056
  ds_read_b64_tr_b16 v[58:59], v8 offset:45568
  ds_read_b64_tr_b16 v[60:61], v8 offset:47104
  ds_read_b64_tr_b16 v[62:63], v8 offset:47616
  s_waitcnt lgkmcnt(6)
  v_mfma_f32_32x32x16_bf16 v[16:31], v[48:51], v[160:163], v[16:31]
  s_waitcnt lgkmcnt(4)
  v_mfma_f32_32x32x16_bf16 v[16:31], v[52:55], v[164:167], v[16:31]
  s_waitcnt lgkmcnt(2)
  v_mfma_f32_32x32x16_bf16 v[16:31], v[56:59], v[168:171], v[16:31]
  s_waitcnt lgkmcnt(0)
  v_mfma_f32_32x32x16_bf16 v[16:31], v[60:63], v[172:175], v[16:31]
  s_waitcnt vmcnt(6)
  s_barrier
  s_add_u32 m0, s48, 32768
  s_mul_i32 s38, s55, 172032
  s_add_u32 s38, s38, s49
  s_add_u32 s38, s38, 896
  buffer_load_dwordx4 v3, s[12:15], s38 offen lds
  s_add_u32 m0, s48, 33792
  s_mul_i32 s38, s55, 172032
  s_add_u32 s38, s38, s49
  s_add_u32 s38, s38, 22400
  buffer_load_dwordx4 v3, s[12:15], s38 offen lds
  s_add_u32 m0, s48, 40960
  s_lshl_b32 s38, s56, 7
  buffer_load_dwordx4 v1, s[8:11], s38 offen lds
  s_add_u32 m0, s48, 41984
  s_lshl_b32 s38, s56, 7
  buffer_load_dwordx4 v2, s[8:11], s38 offen lds
  ds_read_b128 v[176:179], v4 offset:49152
  ds_read_b128 v[180:183], v5 offset:49152
  ds_read_b128 v[184:187], v6 offset:49152
  ds_read_b128 v[188:191], v7 offset:49152
  ds_read_b64_tr_b16 v[48:49], v8 offset:0
  ds_read_b64_tr_b16 v[50:51], v8 offset:512
  ds_read_b64_tr_b16 v[52:53], v8 offset:2048
  ds_read_b64_tr_b16 v[54:55], v8 offset:2560
  ds_read_b64_tr_b16 v[56:57], v8 offset:4096
  ds_read_b64_tr_b16 v[58:59], v8 offset:4608
  ds_read_b64_tr_b16 v[60:61], v8 offset:6144
  ds_read_b64_tr_b16 v[62:63], v8 offset:6656
  s_waitcnt lgkmcnt(6)
  v_mfma_f32_32x32x16_bf16 v[16:31], v[48:51], v[176:179], v[16:31]
  s_waitcnt lgkmcnt(4)
  v_mfma_f32_32x32x16_bf16 v[16:31], v[52:55], v[180:183], v[16:31]
  s_waitcnt lgkmcnt(2)
  v_mfma_f32_32x32x16_bf16 v[16:31], v[56:59], v[184:187], v[16:31]
  s_waitcnt lgkmcnt(0)
  v_mfma_f32_32x32x16_bf16 v[16:31], v[60:63], v[188:191], v[16:31]
  s_waitcnt vmcnt(6)
  s_barrier
  s_add_u32 m0, s48, 49152
  s_mul_i32 s38, s56, 172032
  s_add_u32 s38, s38, s49
  s_add_u32 s38, s38, 896
  buffer_load_dwordx4 v3, s[12:15], s38 offen lds
  s_add_u32 m0, s48, 50176
  s_mul_i32 s38, s56, 172032
  s_add_u32 s38, s38, s49
  s_add_u32 s38, s38, 22400
  buffer_load_dwordx4 v3, s[12:15], s38 offen lds
  s_add_u32 m0, s48, 0
  s_mul_i32 s38, s50, 172032
  s_add_u32 s38, s38, s49
  s_add_u32 s38, s38, 1792
  buffer_load_dwordx4 v3, s[12:15], s38 offen lds
  s_add_u32 m0, s48, 1024
  s_mul_i32 s38, s50, 172032
  s_add_u32 s38, s38, s49
  s_add_u32 s38, s38, 23296
  buffer_load_dwordx4 v3, s[12:15], s38 offen lds
  ds_read_b128 v[192:195], v4 offset:8192
  ds_read_b128 v[196:199], v5 offset:8192
  ds_read_b128 v[200:203], v6 offset:8192
  ds_read_b128 v[204:207], v7 offset:8192
  ds_read_b64_tr_b16 v[48:49], v8 offset:16384
  ds_read_b64_tr_b16 v[50:51], v8 offset:16896
  ds_read_b64_tr_b16 v[52:53], v8 offset:18432
  ds_read_b64_tr_b16 v[54:55], v8 offset:18944
  ds_read_b64_tr_b16 v[56:57], v8 offset:20480
  ds_read_b64_tr_b16 v[58:59], v8 offset:20992
  ds_read_b64_tr_b16 v[60:61], v8 offset:22528
  ds_read_b64_tr_b16 v[62:63], v8 offset:23040
  ds_read_b64_tr_b16 v[64:65], v240 offset:57344
  ds_read_b64_tr_b16 v[66:67], v240 offset:57792
  ds_read_b64_tr_b16 v[68:69], v240 offset:58240
  ds_read_b64_tr_b16 v[70:71], v240 offset:58688
  s_waitcnt lgkmcnt(10)
  v_mfma_f32_32x32x16_bf16 v[16:31], v[48:51], v[192:195], v[16:31]
  s_waitcnt lgkmcnt(8)
  v_mfma_f32_32x32x16_bf16 v[16:31], v[52:55], v[196:199], v[16:31]
  s_waitcnt lgkmcnt(6)
  v_mfma_f32_32x32x16_bf16 v[16:31], v[56:59], v[200:203], v[16:31]
  s_waitcnt lgkmcnt(4)
  v_mfma_f32_32x32x16_bf16 v[16:31], v[60:63], v[204:207], v[16:31]
  s_waitcnt lgkmcnt(0)
  v_cndmask_b32 v70, v70, v15, s[58:59]
  v_cndmask_b32 v71, v71, v15, s[58:59]
  s_waitcnt vmcnt(6)
  s_barrier
  s_add_u32 m0, s48, 8192
  s_mul_i32 s38, s51, 172032
  s_add_u32 s38, s38, s49
  s_add_u32 s38, s38, 1792
  buffer_load_dwordx4 v3, s[12:15], s38 offen lds
  s_add_u32 m0, s48, 9216
  s_mul_i32 s38, s51, 172032
  s_add_u32 s38, s38, s49
  s_add_u32 s38, s38, 23296
  buffer_load_dwordx4 v3, s[12:15], s38 offen lds
  s_add_u32 m0, s48, 16384
  s_mul_i32 s38, s52, 172032
  s_add_u32 s38, s38, s49
  s_add_u32 s38, s38, 1792
  buffer_load_dwordx4 v3, s[12:15], s38 offen lds
  s_add_u32 m0, s48, 17408
  s_mul_i32 s38, s52, 172032
  s_add_u32 s38, s38, s49
  s_add_u32 s38, s38, 23296
  buffer_load_dwordx4 v3, s[12:15], s38 offen lds
  ds_read_b128 v[208:211], v4 offset:24576
  ds_read_b128 v[212:215], v5 offset:24576
  ds_read_b128 v[216:219], v6 offset:24576
  ds_read_b128 v[220:223], v7 offset:24576
  ds_read_b64_tr_b16 v[48:49], v8 offset:32768
  ds_read_b64_tr_b16 v[50:51], v8 offset:33280
  ds_read_b64_tr_b16 v[52:53], v8 offset:34816
  ds_read_b64_tr_b16 v[54:55], v8 offset:35328
  ds_read_b64_tr_b16 v[56:57], v8 offset:36864
  ds_read_b64_tr_b16 v[58:59], v8 offset:37376
  ds_read_b64_tr_b16 v[60:61], v8 offset:38912
  ds_read_b64_tr_b16 v[62:63], v8 offset:39424
  s_waitcnt lgkmcnt(6)
  v_mfma_f32_32x32x16_bf16 v[16:31], v[48:51], v[208:211], v[16:31]
  s_waitcnt lgkmcnt(4)
  v_mfma_f32_32x32x16_bf16 v[16:31], v[52:55], v[212:215], v[16:31]
  s_waitcnt lgkmcnt(2)
  v_mfma_f32_32x32x16_bf16 v[16:31], v[56:59], v[216:219], v[16:31]
  s_waitcnt lgkmcnt(0)
  v_mfma_f32_32x32x16_bf16 v[16:31], v[60:63], v[220:223], v[16:31]
  s_waitcnt vmcnt(6)
  s_barrier
  s_add_u32 m0, s48, 24576
  s_mul_i32 s38, s53, 172032
  s_add_u32 s38, s38, s49
  s_add_u32 s38, s38, 1792
  buffer_load_dwordx4 v3, s[12:15], s38 offen lds
  s_add_u32 m0, s48, 25600
  s_mul_i32 s38, s53, 172032
  s_add_u32 s38, s38, s49
  s_add_u32 s38, s38, 23296
  buffer_load_dwordx4 v3, s[12:15], s38 offen lds
  s_add_u32 m0, s48, 32768
  s_mul_i32 s38, s54, 172032
  s_add_u32 s38, s38, s49
  s_add_u32 s38, s38, 1792
  buffer_load_dwordx4 v3, s[12:15], s38 offen lds
  s_add_u32 m0, s48, 33792
  s_mul_i32 s38, s54, 172032
  s_add_u32 s38, s38, s49
  s_add_u32 s38, s38, 23296
  buffer_load_dwordx4 v3, s[12:15], s38 offen lds
  ds_read_b128 v[224:227], v4 offset:40960
  ds_read_b128 v[228:231], v5 offset:40960
  ds_read_b128 v[232:235], v6 offset:40960
  ds_read_b128 v[236:239], v7 offset:40960
  ds_read_b64_tr_b16 v[48:49], v8 offset:49152
  ds_read_b64_tr_b16 v[50:51], v8 offset:49664
  ds_read_b64_tr_b16 v[52:53], v8 offset:51200
  ds_read_b64_tr_b16 v[54:55], v8 offset:51712
  ds_read_b64_tr_b16 v[56:57], v8 offset:53248
  ds_read_b64_tr_b16 v[58:59], v8 offset:53760
  ds_read_b64_tr_b16 v[60:61], v8 offset:55296
  ds_read_b64_tr_b16 v[62:63], v8 offset:55808
  s_waitcnt lgkmcnt(6)
  v_mfma_f32_32x32x16_bf16 v[16:31], v[48:51], v[224:227], v[16:31]
  s_waitcnt lgkmcnt(4)
  v_mfma_f32_32x32x16_bf16 v[16:31], v[52:55], v[228:231], v[16:31]
  s_waitcnt lgkmcnt(2)
  v_mfma_f32_32x32x16_bf16 v[16:31], v[56:59], v[232:235], v[16:31]
  s_waitcnt lgkmcnt(0)
  v_mfma_f32_32x32x16_bf16 v[16:31], v[60:63], v[236:239], v[16:31]
  s_barrier
  s_mov_b32 s38, 65536
  buffer_load_dword v244, v243, s[24:27], s38 offen sc1
  s_add_u32 m0, s48, 40960
  s_mul_i32 s38, s55, 172032
  s_add_u32 s38, s38, s49
  s_add_u32 s38, s38, 1792
  buffer_load_dwordx4 v3, s[12:15], s38 offen lds
  s_add_u32 m0, s48, 41984
  s_mul_i32 s38, s55, 172032
  s_add_u32 s38, s38, s49
  s_add_u32 s38, s38, 23296
  buffer_load_dwordx4 v3, s[12:15], s38 offen lds
  s_add_u32 m0, s48, 49152
  s_mul_i32 s38, s56, 172032
  s_add_u32 s38, s38, s49
  s_add_u32 s38, s38, 1792
  buffer_load_dwordx4 v3, s[12:15], s38 offen lds
  s_add_u32 m0, s48, 50176
  s_mul_i32 s38, s56, 172032
  s_add_u32 s38, s38, s49
  s_add_u32 s38, s38, 23296
  buffer_load_dwordx4 v3, s[12:15], s38 offen lds
  s_setprio 3
  s_nop 5
  v_cvt_pk_bf16_f32 v48, v16, v17
  v_cvt_pk_bf16_f32 v49, v18, v19
  v_cvt_pk_bf16_f32 v50, v20, v21
  v_cvt_pk_bf16_f32 v51, v22, v23
  v_cvt_pk_bf16_f32 v52, v24, v25
  v_cvt_pk_bf16_f32 v53, v26, v27
  v_cvt_pk_bf16_f32 v54, v28, v29
  v_cvt_pk_bf16_f32 v55, v30, v31
  v_cndmask_b32 v54, v54, v15, s[58:59]
  v_cndmask_b32 v55, v55, v15, s[58:59]
  s_nop 1
  v_mfma_f32_32x32x16_bf16 v[16:31], v[64:67], v[48:51], 0
  v_mfma_f32_32x32x16_bf16 v[16:31], v[68:71], v[52:55], v[16:31]
  s_nop 15
  v_cndmask_b32 v28, v28, v16, s[58:59]
  v_cndmask_b32 v29, v29, v16, s[58:59]
  v_cndmask_b32 v30, v30, v16, s[58:59]
  v_cndmask_b32 v31, v31, v16, s[58:59]
  v_max3_f32 v120, v16, v17, v18
  v_max3_f32 v121, v19, v20, v21
  v_max3_f32 v122, v22, v23, v24
  v_max3_f32 v123, v25, v26, v27
  v_min3_f32 v124, v16, v17, v18
  v_min3_f32 v125, v19, v20, v21
  v_min3_f32 v126, v22, v23, v24
  v_min3_f32 v127, v25, v26, v27
  v_max3_f32 v120, v120, v28, v29
  v_max3_f32 v121, v121, v30, v31
  v_min3_f32 v124, v124, v28, v29
  v_min3_f32 v125, v125, v30, v31
  v_max3_f32 v120, v120, v121, v122
  v_min3_f32 v124, v124, v125, v126
  v_max_f32 v120, v120, v123
  v_min_f32 v124, v124, v127
  v_mov_b32 v121, v120
  v_mov_b32 v125, v124
  s_nop 1
  v_permlane32_swap_b32 v120, v121
  v_permlane32_swap_b32 v124, v125
  v_max_f32 v120, v120, v121
  v_min_f32 v124, v124, v125
  v_mul_f32 v10, s62, v120
  v_mul_f32 v12, s62, v124
  v_fma_f32 v72, v16, s62, -v10
  v_fma_f32 v88, -v16, s62, v12
  v_fma_f32 v73, v17, s62, -v10
  v_fma_f32 v89, -v17, s62, v12
  v_fma_f32 v74, v18, s62, -v10
  v_fma_f32 v90, -v18, s62, v12
  v_fma_f32 v75, v19, s62, -v10
  v_fma_f32 v91, -v19, s62, v12
  v_fma_f32 v76, v20, s62, -v10
  v_fma_f32 v92, -v20, s62, v12
  v_fma_f32 v77, v21, s62, -v10
  v_fma_f32 v93, -v21, s62, v12
  v_fma_f32 v78, v22, s62, -v10
  v_fma_f32 v94, -v22, s62, v12
  v_fma_f32 v79, v23, s62, -v10
  v_fma_f32 v95, -v23, s62, v12
  v_fma_f32 v80, v24, s62, -v10
  v_fma_f32 v96, -v24, s62, v12
  v_fma_f32 v81, v25, s62, -v10
  v_fma_f32 v97, -v25, s62, v12
  v_fma_f32 v82, v26, s62, -v10
  v_fma_f32 v98, -v26, s62, v12
  v_fma_f32 v83, v27, s62, -v10
  v_fma_f32 v99, -v27, s62, v12
  v_fma_f32 v120, v28, s62, -v10
  v_fma_f32 v124, -v28, s62, v12
  v_fma_f32 v121, v29, s62, -v10
  v_fma_f32 v125, -v29, s62, v12
  v_fma_f32 v122, v30, s62, -v10
  v_fma_f32 v126, -v30, s62, v12
  v_fma_f32 v123, v31, s62, -v10
  v_fma_f32 v127, -v31, s62, v12
  v_exp_f32 v72, v72
  v_exp_f32 v88, v88
  v_exp_f32 v73, v73
  v_exp_f32 v89, v89
  v_exp_f32 v74, v74
  v_exp_f32 v90, v90
  v_exp_f32 v75, v75
  v_exp_f32 v91, v91
  v_exp_f32 v76, v76
  v_exp_f32 v92, v92
  v_exp_f32 v77, v77
  v_exp_f32 v93, v93
  v_exp_f32 v78, v78
  v_exp_f32 v94, v94
  v_exp_f32 v79, v79
  v_exp_f32 v95, v95
  v_exp_f32 v80, v80
  v_exp_f32 v96, v96
  v_exp_f32 v81, v81
  v_exp_f32 v97, v97
  v_exp_f32 v82, v82
  v_exp_f32 v98, v98
  v_exp_f32 v83, v83
  v_exp_f32 v99, v99
  s_mov_b64 exec, s[60:61]
  v_exp_f32 v84, v120
  v_exp_f32 v100, v124
  v_exp_f32 v85, v121
  v_exp_f32 v101, v125
  v_exp_f32 v86, v122
  v_exp_f32 v102, v126
  v_exp_f32 v87, v123
  v_exp_f32 v103, v127
  s_mov_b64 exec, -1
  v_add_f32 v120, v72, v76
  v_add_f32 v124, v88, v92
  v_add_f32 v121, v73, v77
  v_add_f32 v125, v89, v93
  v_add_f32 v122, v74, v78
  v_add_f32 v126, v90, v94
  v_add_f32 v123, v75, v79
  v_add_f32 v127, v91, v95
  v_add_f32 v120, v120, v80
  v_add_f32 v124, v124, v96
  v_add_f32 v121, v121, v81
  v_add_f32 v125, v125, v97
  v_add_f32 v122, v122, v82
  v_add_f32 v126, v126, v98
  v_add_f32 v123, v123, v83
  v_add_f32 v127, v127, v99
  v_add_f32 v120, v120, v84
  v_add_f32 v124, v124, v100
  v_add_f32 v121, v121, v85
  v_add_f32 v125, v125, v101
  v_add_f32 v122, v122, v86
  v_add_f32 v126, v126, v102
  v_add_f32 v123, v123, v87
  v_add_f32 v127, v127, v103
  v_add_f32 v120, v120, v121
  v_add_f32 v124, v124, v125
  v_add_f32 v122, v122, v123
  v_add_f32 v126, v126, v127
  v_add_f32 v120, v120, v122
  v_add_f32 v124, v124, v126
  v_mov_b32 v121, v120
  v_mov_b32 v125, v124
  s_nop 1
  v_permlane32_swap_b32 v120, v121
  v_permlane32_swap_b32 v124, v125
  v_add_f32 v120, v120, v121
  v_add_f32 v124, v124, v125
  v_rcp_f32 v120, v120
  v_rcp_f32 v124, v124
  s_nop 0
  v_mul_f32 v72, v120, v72
  v_mul_f32 v88, v124, v88
  v_mul_f32 v73, v120, v73
  v_mul_f32 v89, v124, v89
  v_mul_f32 v74, v120, v74
  v_mul_f32 v90, v124, v90
  v_mul_f32 v75, v120, v75
  v_mul_f32 v91, v124, v91
  v_mul_f32 v76, v120, v76
  v_mul_f32 v92, v124, v92
  v_mul_f32 v77, v120, v77
  v_mul_f32 v93, v124, v93
  v_mul_f32 v78, v120, v78
  v_mul_f32 v94, v124, v94
  v_mul_f32 v79, v120, v79
  v_mul_f32 v95, v124, v95
  v_mul_f32 v80, v120, v80
  v_mul_f32 v96, v124, v96
  v_mul_f32 v81, v120, v81
  v_mul_f32 v97, v124, v97
  v_mul_f32 v82, v120, v82
  v_mul_f32 v98, v124, v98
  v_mul_f32 v83, v120, v83
  v_mul_f32 v99, v124, v99
  v_mul_f32 v84, v120, v84
  v_mul_f32 v100, v124, v100
  v_mul_f32 v85, v120, v85
  v_mul_f32 v101, v124, v101
  v_mul_f32 v86, v120, v86
  v_mul_f32 v102, v124, v102
  v_mul_f32 v87, v120, v87
  v_mul_f32 v103, v124, v103
  v_cvt_pk_bf16_f32 v104, v72, v73
  v_cvt_pk_bf16_f32 v112, v88, v89
  v_cvt_pk_bf16_f32 v105, v74, v75
  v_cvt_pk_bf16_f32 v113, v90, v91
  v_cvt_pk_bf16_f32 v106, v76, v77
  v_cvt_pk_bf16_f32 v114, v92, v93
  v_cvt_pk_bf16_f32 v107, v78, v79
  v_cvt_pk_bf16_f32 v115, v94, v95
  v_cvt_pk_bf16_f32 v108, v80, v81
  v_cvt_pk_bf16_f32 v116, v96, v97
  v_cvt_pk_bf16_f32 v109, v82, v83
  v_cvt_pk_bf16_f32 v117, v98, v99
  v_cvt_pk_bf16_f32 v110, v84, v85
  v_cvt_pk_bf16_f32 v118, v100, v101
  v_cvt_pk_bf16_f32 v111, v86, v87
  v_cvt_pk_bf16_f32 v119, v102, v103
  ds_write_b64 v241, v[104:105] offset:0
  ds_write_b64 v241, v[112:113] offset:64
  ds_write_b64 v241, v[106:107] offset:16
  ds_write_b64 v241, v[114:115] offset:80
  ds_write_b64 v241, v[108:109] offset:32
  ds_write_b64 v241, v[116:117] offset:96
  ds_write_b64 v241, v[110:111] offset:48
  ds_write_b64 v241, v[118:119] offset:112
  s_waitcnt vmcnt(9) lgkmcnt(0)
  s_barrier
  ds_read_b64_tr_b16 v[48:49], v8 offset:0
  ds_read_b64_tr_b16 v[50:51], v8 offset:512
  ds_read_b64_tr_b16 v[52:53], v8 offset:2048
  ds_read_b64_tr_b16 v[54:55], v8 offset:2560
  ds_read_b64_tr_b16 v[56:57], v8 offset:4096
  ds_read_b64_tr_b16 v[58:59], v8 offset:4608
  ds_read_b64_tr_b16 v[60:61], v8 offset:6144
  ds_read_b64_tr_b16 v[62:63], v8 offset:6656
  ds_read_b64_tr_b16 v[72:73], v8 offset:8192
  ds_read_b64_tr_b16 v[74:75], v8 offset:8704
  ds_read_b64_tr_b16 v[76:77], v8 offset:10240
  ds_read_b64_tr_b16 v[78:79], v8 offset:10752
  ds_read_b64_tr_b16 v[80:81], v8 offset:12288
  ds_read_b64_tr_b16 v[82:83], v8 offset:12800
  ds_read_b64_tr_b16 v[88:89], v8 offset:14336
  ds_read_b64_tr_b16 v[90:91], v8 offset:14848
  s_waitcnt lgkmcnt(14)
  v_mfma_f32_32x32x16_bf16 v[32:47], v[128:131], v[48:51], 0
  s_waitcnt lgkmcnt(12)
  v_mfma_f32_32x32x16_bf16 v[32:47], v[132:135], v[52:55], v[32:47]
  s_waitcnt lgkmcnt(10)
  v_mfma_f32_32x32x16_bf16 v[32:47], v[136:139], v[56:59], v[32:47]
  s_waitcnt lgkmcnt(8)
  v_mfma_f32_32x32x16_bf16 v[32:47], v[140:143], v[60:63], v[32:47]
  ds_read_b64_tr_b16 v[48:49], v8 offset:16384
  ds_read_b64_tr_b16 v[50:51], v8 offset:16896
  ds_read_b64_tr_b16 v[52:53], v8 offset:18432
  ds_read_b64_tr_b16 v[54:55], v8 offset:18944
  ds_read_b64_tr_b16 v[56:57], v8 offset:20480
  ds_read_b64_tr_b16 v[58:59], v8 offset:20992
  ds_read_b64_tr_b16 v[60:61], v8 offset:22528
  ds_read_b64_tr_b16 v[62:63], v8 offset:23040
  s_waitcnt lgkmcnt(14)
  v_mfma_f32_32x32x16_bf16 v[32:47], v[144:147], v[72:75], v[32:47]
  s_waitcnt lgkmcnt(12)
  v_mfma_f32_32x32x16_bf16 v[32:47], v[148:151], v[76:79], v[32:47]
  s_waitcnt lgkmcnt(10)
  v_mfma_f32_32x32x16_bf16 v[32:47], v[152:155], v[80:83], v[32:47]
  s_waitcnt lgkmcnt(8)
  v_mfma_f32_32x32x16_bf16 v[32:47], v[156:159], v[88:91], v[32:47]
  s_waitcnt lgkmcnt(6)
  v_mfma_f32_32x32x16_bf16 v[32:47], v[160:163], v[48:51], v[32:47]
  s_waitcnt lgkmcnt(4)
  v_mfma_f32_32x32x16_bf16 v[32:47], v[164:167], v[52:55], v[32:47]
  s_waitcnt lgkmcnt(2)
  v_mfma_f32_32x32x16_bf16 v[32:47], v[168:171], v[56:59], v[32:47]
  s_waitcnt lgkmcnt(0)
  v_mfma_f32_32x32x16_bf16 v[32:47], v[172:175], v[60:63], v[32:47]
  ds_read_b64_tr_b16 v[104:105], v242 offset:0
  ds_read_b64_tr_b16 v[106:107], v242 offset:1088
  ds_read_b64_tr_b16 v[108:109], v242 offset:2176
  ds_read_b64_tr_b16 v[110:111], v242 offset:3264
  ds_read_b64_tr_b16 v[112:113], v242 offset:4352
  ds_read_b64_tr_b16 v[114:115], v242 offset:5440
  ds_read_b64_tr_b16 v[116:117], v242 offset:6528
  ds_read_b64_tr_b16 v[118:119], v242 offset:7616
  s_waitcnt vmcnt(5) lgkmcnt(0)
  s_barrier
  s_add_u32 m0, s48, 0
  s_mul_i32 s38, s50, 172032
  s_add_u32 s38, s38, s49
  s_add_u32 s38, s38, 0
  buffer_load_dwordx4 v3, s[12:15], s38 offen lds
  s_add_u32 m0, s48, 1024
  s_mul_i32 s38, s50, 172032
  s_add_u32 s38, s38, s49
  s_add_u32 s38, s38, 21504
  buffer_load_dwordx4 v3, s[12:15], s38 offen lds
  s_add_u32 m0, s48, 8192
  s_mul_i32 s38, s51, 172032
  s_add_u32 s38, s38, s49
  s_add_u32 s38, s38, 0
  buffer_load_dwordx4 v3, s[12:15], s38 offen lds
  s_add_u32 m0, s48, 9216
  s_mul_i32 s38, s51, 172032
  s_add_u32 s38, s38, s49
  s_add_u32 s38, s38, 21504
  buffer_load_dwordx4 v3, s[12:15], s38 offen lds
  s_add_u32 m0, s48, 16384
  s_mul_i32 s38, s52, 172032
  s_add_u32 s38, s38, s49
  s_add_u32 s38, s38, 0
  buffer_load_dwordx4 v3, s[12:15], s38 offen lds
  s_add_u32 m0, s48, 17408
  s_mul_i32 s38, s52, 172032
  s_add_u32 s38, s38, s49
  s_add_u32 s38, s38, 21504
  buffer_load_dwordx4 v3, s[12:15], s38 offen lds
  ds_read_b64_tr_b16 v[48:49], v8 offset:24576
  ds_read_b64_tr_b16 v[50:51], v8 offset:25088
  ds_read_b64_tr_b16 v[52:53], v8 offset:26624
  ds_read_b64_tr_b16 v[54:55], v8 offset:27136
  ds_read_b64_tr_b16 v[56:57], v8 offset:28672
  ds_read_b64_tr_b16 v[58:59], v8 offset:29184
  ds_read_b64_tr_b16 v[60:61], v8 offset:30720
  ds_read_b64_tr_b16 v[62:63], v8 offset:31232
  ds_read_b64_tr_b16 v[72:73], v8 offset:32768
  ds_read_b64_tr_b16 v[74:75], v8 offset:33280
  ds_read_b64_tr_b16 v[76:77], v8 offset:34816
  ds_read_b64_tr_b16 v[78:79], v8 offset:35328
  ds_read_b64_tr_b16 v[80:81], v8 offset:36864
  ds_read_b64_tr_b16 v[82:83], v8 offset:37376
  ds_read_b64_tr_b16 v[88:89], v8 offset:38912
  ds_read_b64_tr_b16 v[90:91], v8 offset:39424
  s_waitcnt lgkmcnt(14)
  v_mfma_f32_32x32x16_bf16 v[32:47], v[176:179], v[48:51], v[32:47]
  s_waitcnt lgkmcnt(12)
  v_mfma_f32_32x32x16_bf16 v[32:47], v[180:183], v[52:55], v[32:47]
  s_waitcnt lgkmcnt(10)
  v_mfma_f32_32x32x16_bf16 v[32:47], v[184:187], v[56:59], v[32:47]
  s_waitcnt lgkmcnt(8)
  v_mfma_f32_32x32x16_bf16 v[32:47], v[188:191], v[60:63], v[32:47]
  s_waitcnt lgkmcnt(6)
  v_mfma_f32_32x32x16_bf16 v[32:47], v[192:195], v[72:75], v[32:47]
  s_waitcnt lgkmcnt(4)
  v_mfma_f32_32x32x16_bf16 v[32:47], v[196:199], v[76:79], v[32:47]
  s_waitcnt lgkmcnt(2)
  v_mfma_f32_32x32x16_bf16 v[32:47], v[200:203], v[80:83], v[32:47]
  s_waitcnt lgkmcnt(0)
  v_mfma_f32_32x32x16_bf16 v[32:47], v[204:207], v[88:91], v[32:47]
  s_waitcnt vmcnt(6)
  s_barrier
  s_add_u32 m0, s48, 24576
  s_mul_i32 s38, s53, 172032
  s_add_u32 s38, s38, s49
  s_add_u32 s38, s38, 0
  buffer_load_dwordx4 v3, s[12:15], s38 offen lds
  s_add_u32 m0, s48, 25600
  s_mul_i32 s38, s53, 172032
  s_add_u32 s38, s38, s49
  s_add_u32 s38, s38, 21504
  buffer_load_dwordx4 v3, s[12:15], s38 offen lds
  s_add_u32 m0, s48, 32768
  s_mul_i32 s38, s54, 172032
  s_add_u32 s38, s38, s49
  s_add_u32 s38, s38, 0
  buffer_load_dwordx4 v3, s[12:15], s38 offen lds
  s_add_u32 m0, s48, 33792
  s_mul_i32 s38, s54, 172032
  s_add_u32 s38, s38, s49
  s_add_u32 s38, s38, 21504
  buffer_load_dwordx4 v3, s[12:15], s38 offen lds
  ds_read_b64_tr_b16 v[48:49], v8 offset:40960
  ds_read_b64_tr_b16 v[50:51], v8 offset:41472
  ds_read_b64_tr_b16 v[52:53], v8 offset:43008
  ds_read_b64_tr_b16 v[54:55], v8 offset:43520
  ds_read_b64_tr_b16 v[56:57], v8 offset:45056
  ds_read_b64_tr_b16 v[58:59], v8 offset:45568
  ds_read_b64_tr_b16 v[60:61], v8 offset:47104
  ds_read_b64_tr_b16 v[62:63], v8 offset:47616
  ds_read_b64_tr_b16 v[72:73], v8 offset:49152
  ds_read_b64_tr_b16 v[74:75], v8 offset:49664
  ds_read_b64_tr_b16 v[76:77], v8 offset:51200
  ds_read_b64_tr_b16 v[78:79], v8 offset:51712
  ds_read_b64_tr_b16 v[80:81], v8 offset:53248
  ds_read_b64_tr_b16 v[82:83], v8 offset:53760
  ds_read_b64_tr_b16 v[88:89], v8 offset:55296
  ds_read_b64_tr_b16 v[90:91], v8 offset:55808
  s_waitcnt lgkmcnt(14)
  v_mfma_f32_32x32x16_bf16 v[32:47], v[208:211], v[48:51], v[32:47]
  s_waitcnt lgkmcnt(12)
  v_mfma_f32_32x32x16_bf16 v[32:47], v[212:215], v[52:55], v[32:47]
  s_waitcnt lgkmcnt(10)
  v_mfma_f32_32x32x16_bf16 v[32:47], v[216:219], v[56:59], v[32:47]
  s_waitcnt lgkmcnt(8)
  v_mfma_f32_32x32x16_bf16 v[32:47], v[220:223], v[60:63], v[32:47]
  s_waitcnt lgkmcnt(6)
  v_mfma_f32_32x32x16_bf16 v[32:47], v[224:227], v[72:75], v[32:47]
  s_waitcnt lgkmcnt(4)
  v_mfma_f32_32x32x16_bf16 v[32:47], v[228:231], v[76:79], v[32:47]
  s_waitcnt lgkmcnt(2)
  v_mfma_f32_32x32x16_bf16 v[32:47], v[232:235], v[80:83], v[32:47]
  s_waitcnt lgkmcnt(0)
  v_mfma_f32_32x32x16_bf16 v[32:47], v[236:239], v[88:91], v[32:47]
  v_and_b32 v10, 31, v0
  v_cmp_eq_u32 vcc, 28, v10
  v_mov_b32 v11, 0x3f803f80
  v_add_u32 v12, s48, v9
  s_xor_b32 s38, s48, 4096
  v_add_u32 v13, s38, v9
  s_waitcnt lgkmcnt(0)
  s_add_u32 s32, s32, 2654435769
  s_nop 5
  v_cvt_pk_bf16_f32 v48, v32, v33
  v_cvt_pk_bf16_f32 v49, v34, v35
  v_cvt_pk_bf16_f32 v50, v36, v37
  v_cvt_pk_bf16_f32 v51, v38, v39
  v_cvt_pk_bf16_f32 v52, v40, v41
  v_cvt_pk_bf16_f32 v53, v42, v43
  v_cvt_pk_bf16_f32 v54, v44, v45
  v_cvt_pk_bf16_f32 v55, v46, v47
  v_cndmask_b32 v48, v48, v11, vcc
  v_cndmask_b32 v49, v49, v11, vcc
  v_cndmask_b32 v50, v50, v11, vcc
  v_cndmask_b32 v51, v51, v11, vcc
  v_cndmask_b32 v52, v52, v11, vcc
  v_cndmask_b32 v53, v53, v11, vcc
  v_cndmask_b32 v54, v54, v11, vcc
  v_cndmask_b32 v55, v55, v11, vcc
  s_barrier
  ds_write_b128 v12, v[48:51] offset:40960
  ds_write_b128 v12, v[52:55] offset:41984
  s_waitcnt lgkmcnt(0)
  s_barrier
  ds_read_b128 v[56:59], v13 offset:40960
  ds_read_b128 v[60:63], v13 offset:41984
  s_add_u32 m0, s48, 49152
  s_mul_i32 s38, s56, 172032
  s_add_u32 s38, s38, s49
  s_add_u32 s38, s38, 0
  buffer_load_dwordx4 v3, s[12:15], s38 offen lds
  s_add_u32 m0, s48, 50176
  s_mul_i32 s38, s56, 172032
  s_add_u32 s38, s38, s49
  s_add_u32 s38, s38, 21504
  buffer_load_dwordx4 v3, s[12:15], s38 offen lds
  s_mov_b32 s67, 0
  s_mov_b32 s38, 65536
Lcfp_2:
  v_cmp_ne_u32 vcc, s32, v244
  s_cbranch_vccz Lcf_1
  s_sleep 4
  buffer_load_dword v244, v243, s[24:27], s38 offen sc1
  s_waitcnt vmcnt(0)
  s_add_u32 s67, s67, 1
  s_cmp_lt_u32 s67, 20000
  s_cbranch_scc1 Lcfp_2
Lcf_1:
  s_cmp_lg_u32 s34, 0
  s_cbranch_scc1 Lrt1_3
  v_mfma_f32_32x32x16_bf16 v[16:31], v[104:107], v[48:51], 0
  v_mfma_f32_32x32x16_bf16 v[16:31], v[108:111], v[52:55], v[16:31]
  s_waitcnt lgkmcnt(0)
  v_mfma_f32_32x32x16_bf16 v[16:31], v[112:115], v[56:59], v[16:31]
  v_mfma_f32_32x32x16_bf16 v[16:31], v[116:119], v[60:63], v[16:31]
  s_branch Lrtd_4
Lrt1_3:
  v_mfma_f32_32x32x16_bf16 v[16:31], v[112:115], v[48:51], 0
  v_mfma_f32_32x32x16_bf16 v[16:31], v[116:119], v[52:55], v[16:31]
  s_waitcnt lgkmcnt(0)
  v_mfma_f32_32x32x16_bf16 v[16:31], v[104:107], v[56:59], v[16:31]
  v_mfma_f32_32x32x16_bf16 v[16:31], v[108:111], v[60:63], v[16:31]
Lrtd_4:
  s_nop 13
  v_cvt_pk_bf16_f32 v72, v16, v17
  v_cvt_pk_bf16_f32 v73, v18, v19
  v_cvt_pk_bf16_f32 v74, v20, v21
  v_cvt_pk_bf16_f32 v75, v22, v23
  v_cvt_pk_bf16_f32 v76, v24, v25
  v_cvt_pk_bf16_f32 v77, v26, v27
  v_cvt_pk_bf16_f32 v78, v28, v29
  v_cvt_pk_bf16_f32 v79, v30, v31
  buffer_store_dwordx4 v[72:75], v9, s[24:27], s64 offen sc1
  buffer_store_dwordx4 v[76:79], v9, s[24:27], s64 offen offset:1024 sc1
  v_mov_b32 v10, -1
  v_mov_b32 v11, -1
  v_mov_b32 v12, -1
  v_mov_b32 v13, -1
  buffer_store_dwordx4 v[10:13], v9, s[24:27], s65 offen sc1
  buffer_store_dwordx4 v[10:13], v9, s[24:27], s65 offen offset:1024 sc1
  s_waitcnt vmcnt(6)
  s_barrier
  s_add_u32 m0, s48, 40960
  s_mul_i32 s38, s55, 172032
  s_add_u32 s38, s38, s49
  s_add_u32 s38, s38, 0
  buffer_load_dwordx4 v3, s[12:15], s38 offen lds
  s_add_u32 m0, s48, 41984
  s_mul_i32 s38, s55, 172032
  s_add_u32 s38, s38, s49
  s_add_u32 s38, s38, 21504
  buffer_load_dwordx4 v3, s[12:15], s38 offen lds
  ds_read_b64_tr_b16 v[48:49], v8 offset:0
  ds_read_b64_tr_b16 v[50:51], v8 offset:512
  ds_read_b64_tr_b16 v[52:53], v8 offset:2048
  ds_read_b64_tr_b16 v[54:55], v8 offset:2560
  ds_read_b64_tr_b16 v[56:57], v8 offset:4096
  ds_read_b64_tr_b16 v[58:59], v8 offset:4608
  ds_read_b64_tr_b16 v[60:61], v8 offset:6144
  ds_read_b64_tr_b16 v[62:63], v8 offset:6656
  ds_read_b64_tr_b16 v[72:73], v8 offset:8192
  ds_read_b64_tr_b16 v[74:75], v8 offset:8704
  ds_read_b64_tr_b16 v[76:77], v8 offset:10240
  ds_read_b64_tr_b16 v[78:79], v8 offset:10752
  ds_read_b64_tr_b16 v[80:81], v8 offset:12288
  ds_read_b64_tr_b16 v[82:83], v8 offset:12800
  ds_read_b64_tr_b16 v[88:89], v8 offset:14336
  ds_read_b64_tr_b16 v[90:91], v8 offset:14848
  s_waitcnt lgkmcnt(14)
  v_mfma_f32_32x32x16_bf16 v[16:31], v[48:51], v[128:131], 0
  s_waitcnt lgkmcnt(12)
  v_mfma_f32_32x32x16_bf16 v[16:31], v[52:55], v[132:135], v[16:31]
  s_waitcnt lgkmcnt(10)
  v_mfma_f32_32x32x16_bf16 v[16:31], v[56:59], v[136:139], v[16:31]
  s_waitcnt lgkmcnt(8)
  v_mfma_f32_32x32x16_bf16 v[16:31], v[60:63], v[140:143], v[16:31]
  ds_read_b64_tr_b16 v[48:49], v8 offset:16384
  ds_read_b64_tr_b16 v[50:51], v8 offset:16896
  ds_read_b64_tr_b16 v[52:53], v8 offset:18432
  ds_read_b64_tr_b16 v[54:55], v8 offset:18944
  ds_read_b64_tr_b16 v[56:57], v8 offset:20480
  ds_read_b64_tr_b16 v[58:59], v8 offset:20992
  ds_read_b64_tr_b16 v[60:61], v8 offset:22528
  ds_read_b64_tr_b16 v[62:63], v8 offset:23040
  s_waitcnt lgkmcnt(14)
  v_mfma_f32_32x32x16_bf16 v[16:31], v[72:75], v[144:147], v[16:31]
  s_waitcnt lgkmcnt(12)
  v_mfma_f32_32x32x16_bf16 v[16:31], v[76:79], v[148:151], v[16:31]
  s_waitcnt lgkmcnt(10)
  v_mfma_f32_32x32x16_bf16 v[16:31], v[80:83], v[152:155], v[16:31]
  s_waitcnt lgkmcnt(8)
  v_mfma_f32_32x32x16_bf16 v[16:31], v[88:91], v[156:159], v[16:31]
  ds_read_b64_tr_b16 v[72:73], v8 offset:24576
  ds_read_b64_tr_b16 v[74:75], v8 offset:25088
  ds_read_b64_tr_b16 v[76:77], v8 offset:26624
  ds_read_b64_tr_b16 v[78:79], v8 offset:27136
  ds_read_b64_tr_b16 v[80:81], v8 offset:28672
  ds_read_b64_tr_b16 v[82:83], v8 offset:29184
  ds_read_b64_tr_b16 v[88:89], v8 offset:30720
  ds_read_b64_tr_b16 v[90:91], v8 offset:31232
  s_waitcnt lgkmcnt(14)
  v_mfma_f32_32x32x16_bf16 v[16:31], v[48:51], v[160:163], v[16:31]
  s_waitcnt lgkmcnt(12)
  v_mfma_f32_32x32x16_bf16 v[16:31], v[52:55], v[164:167], v[16:31]
  s_waitcnt lgkmcnt(10)
  v_mfma_f32_32x32x16_bf16 v[16:31], v[56:59], v[168:171], v[16:31]
  s_waitcnt lgkmcnt(8)
  v_mfma_f32_32x32x16_bf16 v[16:31], v[60:63], v[172:175], v[16:31]
  ds_read_b64_tr_b16 v[48:49], v8 offset:32768
  ds_read_b64_tr_b16 v[50:51], v8 offset:33280
  ds_read_b64_tr_b16 v[52:53], v8 offset:34816
  ds_read_b64_tr_b16 v[54:55], v8 offset:35328
  ds_read_b64_tr_b16 v[56:57], v8 offset:36864
  ds_read_b64_tr_b16 v[58:59], v8 offset:37376
  ds_read_b64_tr_b16 v[60:61], v8 offset:38912
  ds_read_b64_tr_b16 v[62:63], v8 offset:39424
  s_waitcnt lgkmcnt(14)
  v_mfma_f32_32x32x16_bf16 v[16:31], v[72:75], v[176:179], v[16:31]
  s_waitcnt lgkmcnt(12)
  v_mfma_f32_32x32x16_bf16 v[16:31], v[76:79], v[180:183], v[16:31]
  s_waitcnt lgkmcnt(10)
  v_mfma_f32_32x32x16_bf16 v[16:31], v[80:83], v[184:187], v[16:31]
  s_waitcnt lgkmcnt(8)
  v_mfma_f32_32x32x16_bf16 v[16:31], v[88:91], v[188:191], v[16:31]
  s_waitcnt lgkmcnt(6)
  v_mfma_f32_32x32x16_bf16 v[16:31], v[48:51], v[192:195], v[16:31]
  s_waitcnt lgkmcnt(4)
  v_mfma_f32_32x32x16_bf16 v[16:31], v[52:55], v[196:199], v[16:31]
  s_waitcnt lgkmcnt(2)
  v_mfma_f32_32x32x16_bf16 v[16:31], v[56:59], v[200:203], v[16:31]
  s_waitcnt lgkmcnt(0)
  v_mfma_f32_32x32x16_bf16 v[16:31], v[60:63], v[204:207], v[16:31]
  s_and_b32 s38, s37, 3
  s_lshl_b32 s45, s38, 8
  s_lshl_b32 s38, s38, 7
  s_lshl_b32 s39, s33, 5
  s_add_u32 s42, s38, s39
  s_cmp_lt_u32 s42, 448
  s_cselect_b32 s43, 1, 0
  s_lshl_b32 s41, s33, 10
  v_lshrrev_b32 v10, 4, v0
  v_mul_u32_u24 v1, 896, v10
  v_lshlrev_b32 v11, 2, v10
  v_and_b32 v12, 15, v0
  v_xor_b32 v11, v11, v12
  v_lshlrev_b32 v11, 4, v11
  v_add_u32 v1, v1, v11
  v_add_u32 v1, s45, v1
  v_lshrrev_b32 v10, 5, v0
  v_lshlrev_b32 v10, 2, v10
  v_bfe_u32 v11, v0, 2, 2
  v_add_u32 v10, v10, v11
  v_lshlrev_b32 v10, 8, v10
  v_xor_b32 v11, s33, v11
  v_lshlrev_b32 v11, 6, v11
  v_add_u32 v10, v10, v11
  v_bfe_u32 v11, v0, 4, 1
  v_lshlrev_b32 v11, 5, v11
  v_add_u32 v10, v10, v11
  v_and_b32 v11, 3, v0
  v_lshlrev_b32 v11, 3, v11
  v_add_u32 v2, v10, v11
  s_waitcnt vmcnt(0)
  s_barrier
  s_cmp_lg_u32 s33, 3
  s_cbranch_scc1 Lfb2_5
  s_lshl_b32 s38, s2, 7
  s_add_u32 s38, s38, 196608
  v_mov_b32 v10, s32
  v_mov_b32 v11, s32
  v_mov_b32 v12, s32
  v_mov_b32 v13, s32
  s_mov_b64 exec, 0xff
  buffer_store_dwordx4 v[10:13], v9, s[24:27], s38 offen sc1
  s_mov_b64 exec, -1
  s_nop 1
Lfb2_5:
  s_cmp_lg_u32 s33, 0
  s_cbranch_scc1 L1a_i_6
  s_mul_i32 s38, s37, 270336
  s_lshl_b32 s39, s36, 8
  s_add_u32 s38, s38, s39
  s_add_u32 s40, s38, 1048576
  s_add_u32 s38, s40, 0
  buffer_load_dwordx4 v[32:35], v247, s[24:27], s38 offen sc1
  s_add_u32 s38, s40, 33792
  buffer_load_dwordx4 v[36:39], v247, s[24:27], s38 offen sc1
  s_add_u32 s38, s40, 67584
  buffer_load_dwordx4 v[40:43], v247, s[24:27], s38 offen sc1
  s_add_u32 s38, s40, 101376
  buffer_load_dwordx4 v[44:47], v247, s[24:27], s38 offen sc1
  s_add_u32 s38, s40, 135168
  buffer_load_dwordx4 v[104:107], v247, s[24:27], s38 offen sc1
  s_add_u32 s38, s40, 168960
  buffer_load_dwordx4 v[108:111], v247, s[24:27], s38 offen sc1
  s_add_u32 s38, s40, 202752
  buffer_load_dwordx4 v[112:115], v247, s[24:27], s38 offen sc1
  s_add_u32 s38, s40, 236544
  buffer_load_dwordx4 v[116:119], v247, s[24:27], s38 offen sc1
L1a_i_6:
  ds_read_b64_tr_b16 v[48:49], v8 offset:40960
  ds_read_b64_tr_b16 v[50:51], v8 offset:41472
  ds_read_b64_tr_b16 v[52:53], v8 offset:43008
  ds_read_b64_tr_b16 v[54:55], v8 offset:43520
  ds_read_b64_tr_b16 v[56:57], v8 offset:45056
  ds_read_b64_tr_b16 v[58:59], v8 offset:45568
  ds_read_b64_tr_b16 v[60:61], v8 offset:47104
  ds_read_b64_tr_b16 v[62:63], v8 offset:47616
  ds_read_b64_tr_b16 v[72:73], v8 offset:49152
  ds_read_b64_tr_b16 v[74:75], v8 offset:49664
  ds_read_b64_tr_b16 v[76:77], v8 offset:51200
  ds_read_b64_tr_b16 v[78:79], v8 offset:51712
  ds_read_b64_tr_b16 v[80:81], v8 offset:53248
  ds_read_b64_tr_b16 v[82:83], v8 offset:53760
  ds_read_b64_tr_b16 v[88:89], v8 offset:55296
  ds_read_b64_tr_b16 v[90:91], v8 offset:55808
  s_waitcnt lgkmcnt(14)
  v_mfma_f32_32x32x16_bf16 v[16:31], v[48:51], v[208:211], v[16:31]
  s_waitcnt lgkmcnt(12)
  v_mfma_f32_32x32x16_bf16 v[16:31], v[52:55], v[212:215], v[16:31]
  s_waitcnt lgkmcnt(10)
  v_mfma_f32_32x32x16_bf16 v[16:31], v[56:59], v[216:219], v[16:31]
  s_waitcnt lgkmcnt(8)
  v_mfma_f32_32x32x16_bf16 v[16:31], v[60:63], v[220:223], v[16:31]
  s_waitcnt lgkmcnt(6)
  v_mfma_f32_32x32x16_bf16 v[16:31], v[72:75], v[224:227], v[16:31]
  s_waitcnt lgkmcnt(4)
  v_mfma_f32_32x32x16_bf16 v[16:31], v[76:79], v[228:231], v[16:31]
  s_waitcnt lgkmcnt(2)
  v_mfma_f32_32x32x16_bf16 v[16:31], v[80:83], v[232:235], v[16:31]
  s_waitcnt lgkmcnt(0)
  v_mfma_f32_32x32x16_bf16 v[16:31], v[88:91], v[236:239], v[16:31]
  s_waitcnt lgkmcnt(0)
  s_barrier
  s_mul_i32 s46, s33, 3584
  v_add_u32 v6, 32768, v2
  s_nop 7
  v_cvt_pk_bf16_f32 v48, v16, v17
  v_cvt_pk_bf16_f32 v49, v18, v19
  v_cvt_pk_bf16_f32 v50, v20, v21
  v_cvt_pk_bf16_f32 v51, v22, v23
  v_cvt_pk_bf16_f32 v52, v24, v25
  v_cvt_pk_bf16_f32 v53, v26, v27
  v_cvt_pk_bf16_f32 v54, v28, v29
  v_cvt_pk_bf16_f32 v55, v30, v31
  v_cndmask_b32 v54, v54, v15, s[58:59]
  v_cndmask_b32 v55, v55, v15, s[58:59]
  s_nop 1
  v_mfma_f32_32x32x16_bf16 v[16:31], v[64:67], v[48:51], 0
  v_mfma_f32_32x32x16_bf16 v[16:31], v[68:71], v[52:55], v[16:31]
  s_nop 15
  s_cmp_lg_u32 s33, 0
  s_cbranch_scc1 L1a_skip_7
  v_and_b32 v10, 15, v0
  v_lshlrev_b32 v10, 4, v10
  v_lshrrev_b32 v11, 4, v0
  v_lshlrev_b32 v11, 3, v11
  v_add_u32 v10, v10, v11
  s_lshl_b32 s47, s36, 8
  s_add_u32 s47, s47, s66
  s_mov_b32 s67, 0
L1a_poll_8:
  s_waitcnt vmcnt(7)
  v_mfma_f32_16x16x32_bf16 v[48:51], v[248:251], v[32:35], 0
  s_waitcnt vmcnt(6)
  v_mfma_f32_16x16x32_bf16 v[48:51], v[248:251], v[36:39], v[48:51]
  s_waitcnt vmcnt(5)
  v_mfma_f32_16x16x32_bf16 v[48:51], v[248:251], v[40:43], v[48:51]
  s_waitcnt vmcnt(4)
  v_mfma_f32_16x16x32_bf16 v[48:51], v[248:251], v[44:47], v[48:51]
  s_waitcnt vmcnt(3)
  v_mfma_f32_16x16x32_bf16 v[48:51], v[248:251], v[104:107], v[48:51]
  s_waitcnt vmcnt(2)
  v_mfma_f32_16x16x32_bf16 v[48:51], v[248:251], v[108:111], v[48:51]
  s_waitcnt vmcnt(1)
  v_mfma_f32_16x16x32_bf16 v[48:51], v[248:251], v[112:115], v[48:51]
  s_waitcnt vmcnt(0)
  v_mfma_f32_16x16x32_bf16 v[48:51], v[248:251], v[116:119], v[48:51]
  s_nop 7
  v_cmp_u_f32 vcc, v48, v48
  s_cbranch_vccz L1a_done_9
  s_add_u32 s38, s40, 0
  buffer_load_dwordx4 v[32:35], v247, s[24:27], s38 offen sc1
  s_add_u32 s38, s40, 33792
  buffer_load_dwordx4 v[36:39], v247, s[24:27], s38 offen sc1
  s_add_u32 s38, s40, 67584
  buffer_load_dwordx4 v[40:43], v247, s[24:27], s38 offen sc1
  s_add_u32 s38, s40, 101376
  buffer_load_dwordx4 v[44:47], v247, s[24:27], s38 offen sc1
  s_add_u32 s38, s40, 135168
  buffer_load_dwordx4 v[104:107], v247, s[24:27], s38 offen sc1
  s_add_u32 s38, s40, 168960
  buffer_load_dwordx4 v[108:111], v247, s[24:27], s38 offen sc1
  s_add_u32 s38, s40, 202752
  buffer_load_dwordx4 v[112:115], v247, s[24:27], s38 offen sc1
  s_add_u32 s38, s40, 236544
  buffer_load_dwordx4 v[116:119], v247, s[24:27], s38 offen sc1
  s_add_u32 s67, s67, 1
  s_cmp_lt_u32 s67, 20000
  s_cbranch_scc1 L1a_poll_8
  s_waitcnt vmcnt(0)
L1a_done_9:
  v_cvt_pk_bf16_f32 v52, v48, v49
  v_cvt_pk_bf16_f32 v53, v50, v51
  s_mov_b64 exec, s[60:61]
  buffer_store_dwordx2 v[52:53], v10, s[24:27], s47 offen sc1
  s_mov_b64 exec, -1
L1a_skip_7:
  s_add_u32 m0, s41, 0
  s_add_u32 s38, s46, 0
  buffer_load_dwordx4 v1, s[16:19], s38 offen lds
  s_add_u32 m0, s41, 4096
  s_add_u32 s38, s46, 14336
  buffer_load_dwordx4 v1, s[16:19], s38 offen lds
  s_add_u32 m0, s41, 8192
  s_add_u32 s38, s46, 28672
  buffer_load_dwordx4 v1, s[16:19], s38 offen lds
  s_add_u32 m0, s41, 12288
  s_add_u32 s38, s46, 43008
  buffer_load_dwordx4 v1, s[16:19], s38 offen lds
  s_add_u32 m0, s41, 16384
  s_add_u32 s38, s46, 57344
  buffer_load_dwordx4 v1, s[16:19], s38 offen lds
  s_add_u32 m0, s41, 20480
  s_add_u32 s38, s46, 71680
  buffer_load_dwordx4 v1, s[16:19], s38 offen lds
  s_add_u32 m0, s41, 24576
  s_add_u32 s38, s46, 86016
  buffer_load_dwordx4 v1, s[16:19], s38 offen lds
  v_cndmask_b32 v28, v28, v16, s[58:59]
  v_cndmask_b32 v29, v29, v16, s[58:59]
  v_cndmask_b32 v30, v30, v16, s[58:59]
  v_cndmask_b32 v31, v31, v16, s[58:59]
  v_max3_f32 v120, v16, v17, v18
  v_max3_f32 v121, v19, v20, v21
  v_max3_f32 v122, v22, v23, v24
  v_max3_f32 v123, v25, v26, v27
  v_min3_f32 v124, v16, v17, v18
  v_min3_f32 v125, v19, v20, v21
  v_min3_f32 v126, v22, v23, v24
  v_min3_f32 v127, v25, v26, v27
  v_max3_f32 v120, v120, v28, v29
  v_max3_f32 v121, v121, v30, v31
  v_min3_f32 v124, v124, v28, v29
  v_min3_f32 v125, v125, v30, v31
  v_max3_f32 v120, v120, v121, v122
  v_min3_f32 v124, v124, v125, v126
  v_max_f32 v120, v120, v123
  v_min_f32 v124, v124, v127
  v_mov_b32 v121, v120
  v_mov_b32 v125, v124
  s_nop 1
  v_permlane32_swap_b32 v120, v121
  v_permlane32_swap_b32 v124, v125
  v_max_f32 v120, v120, v121
  v_min_f32 v124, v124, v125
  v_mul_f32 v10, s62, v120
  v_mul_f32 v12, s62, v124
  v_fma_f32 v72, v16, s62, -v10
  v_fma_f32 v88, -v16, s62, v12
  v_fma_f32 v73, v17, s62, -v10
  v_fma_f32 v89, -v17, s62, v12
  v_fma_f32 v74, v18, s62, -v10
  v_fma_f32 v90, -v18, s62, v12
  v_fma_f32 v75, v19, s62, -v10
  v_fma_f32 v91, -v19, s62, v12
  v_fma_f32 v76, v20, s62, -v10
  v_fma_f32 v92, -v20, s62, v12
  v_fma_f32 v77, v21, s62, -v10
  v_fma_f32 v93, -v21, s62, v12
  v_fma_f32 v78, v22, s62, -v10
  v_fma_f32 v94, -v22, s62, v12
  v_fma_f32 v79, v23, s62, -v10
  v_fma_f32 v95, -v23, s62, v12
  v_fma_f32 v80, v24, s62, -v10
  v_fma_f32 v96, -v24, s62, v12
  v_fma_f32 v81, v25, s62, -v10
  v_fma_f32 v97, -v25, s62, v12
  v_fma_f32 v82, v26, s62, -v10
  v_fma_f32 v98, -v26, s62, v12
  v_fma_f32 v83, v27, s62, -v10
  v_fma_f32 v99, -v27, s62, v12
  v_fma_f32 v120, v28, s62, -v10
  v_fma_f32 v124, -v28, s62, v12
  v_fma_f32 v121, v29, s62, -v10
  v_fma_f32 v125, -v29, s62, v12
  v_fma_f32 v122, v30, s62, -v10
  v_fma_f32 v126, -v30, s62, v12
  v_fma_f32 v123, v31, s62, -v10
  v_fma_f32 v127, -v31, s62, v12
  v_exp_f32 v72, v72
  v_exp_f32 v88, v88
  v_exp_f32 v73, v73
  v_exp_f32 v89, v89
  v_exp_f32 v74, v74
  v_exp_f32 v90, v90
  v_exp_f32 v75, v75
  v_exp_f32 v91, v91
  v_exp_f32 v76, v76
  v_exp_f32 v92, v92
  v_exp_f32 v77, v77
  v_exp_f32 v93, v93
  v_exp_f32 v78, v78
  v_exp_f32 v94, v94
  v_exp_f32 v79, v79
  v_exp_f32 v95, v95
  v_exp_f32 v80, v80
  v_exp_f32 v96, v96
  v_exp_f32 v81, v81
  v_exp_f32 v97, v97
  v_exp_f32 v82, v82
  v_exp_f32 v98, v98
  v_exp_f32 v83, v83
  v_exp_f32 v99, v99
  s_mov_b64 exec, s[60:61]
  v_exp_f32 v84, v120
  v_exp_f32 v100, v124
  v_exp_f32 v85, v121
  v_exp_f32 v101, v125
  v_exp_f32 v86, v122
  v_exp_f32 v102, v126
  v_exp_f32 v87, v123
  v_exp_f32 v103, v127
  s_mov_b64 exec, -1
  s_add_u32 m0, s41, 28672
  s_add_u32 s38, s46, 100352
  buffer_load_dwordx4 v1, s[16:19], s38 offen lds
  s_add_u32 m0, s41, 32768
  s_add_u32 s38, s46, 114688
  buffer_load_dwordx4 v1, s[16:19], s38 offen lds
  s_add_u32 m0, s41, 36864
  s_add_u32 s38, s46, 129024
  buffer_load_dwordx4 v1, s[16:19], s38 offen lds
  s_add_u32 m0, s41, 40960
  s_add_u32 s38, s46, 143360
  buffer_load_dwordx4 v1, s[16:19], s38 offen lds
  s_add_u32 m0, s41, 45056
  s_add_u32 s38, s46, 157696
  buffer_load_dwordx4 v1, s[16:19], s38 offen lds
  s_add_u32 m0, s41, 49152
  s_add_u32 s38, s46, 172032
  buffer_load_dwordx4 v1, s[16:19], s38 offen lds
  s_add_u32 m0, s41, 53248
  s_add_u32 s38, s46, 186368
  buffer_load_dwordx4 v1, s[16:19], s38 offen lds
  v_add_f32 v120, v72, v76
  v_add_f32 v124, v88, v92
  v_add_f32 v121, v73, v77
  v_add_f32 v125, v89, v93
  v_add_f32 v122, v74, v78
  v_add_f32 v126, v90, v94
  v_add_f32 v123, v75, v79
  v_add_f32 v127, v91, v95
  v_add_f32 v120, v120, v80
  v_add_f32 v124, v124, v96
  v_add_f32 v121, v121, v81
  v_add_f32 v125, v125, v97
  v_add_f32 v122, v122, v82
  v_add_f32 v126, v126, v98
  v_add_f32 v123, v123, v83
  v_add_f32 v127, v127, v99
  v_add_f32 v120, v120, v84
  v_add_f32 v124, v124, v100
  v_add_f32 v121, v121, v85
  v_add_f32 v125, v125, v101
  v_add_f32 v122, v122, v86
  v_add_f32 v126, v126, v102
  v_add_f32 v123, v123, v87
  v_add_f32 v127, v127, v103
  v_add_f32 v120, v120, v121
  v_add_f32 v124, v124, v125
  v_add_f32 v122, v122, v123
  v_add_f32 v126, v126, v127
  v_add_f32 v120, v120, v122
  v_add_f32 v124, v124, v126
  v_mov_b32 v121, v120
  v_mov_b32 v125, v124
  s_nop 1
  v_permlane32_swap_b32 v120, v121
  v_permlane32_swap_b32 v124, v125
  v_add_f32 v120, v120, v121
  v_add_f32 v124, v124, v125
  v_rcp_f32 v120, v120
  v_rcp_f32 v124, v124
  s_nop 0
  v_mul_f32 v72, v120, v72
  v_mul_f32 v88, v124, v88
  v_mul_f32 v73, v120, v73
  v_mul_f32 v89, v124, v89
  v_mul_f32 v74, v120, v74
  v_mul_f32 v90, v124, v90
  v_mul_f32 v75, v120, v75
  v_mul_f32 v91, v124, v91
  v_mul_f32 v76, v120, v76
  v_mul_f32 v92, v124, v92
  v_mul_f32 v77, v120, v77
  v_mul_f32 v93, v124, v93
  v_mul_f32 v78, v120, v78
  v_mul_f32 v94, v124, v94
  v_mul_f32 v79, v120, v79
  v_mul_f32 v95, v124, v95
  v_mul_f32 v80, v120, v80
  v_mul_f32 v96, v124, v96
  v_mul_f32 v81, v120, v81
  v_mul_f32 v97, v124, v97
  v_mul_f32 v82, v120, v82
  v_mul_f32 v98, v124, v98
  v_mul_f32 v83, v120, v83
  v_mul_f32 v99, v124, v99
  v_mul_f32 v84, v120, v84
  v_mul_f32 v100, v124, v100
  v_mul_f32 v85, v120, v85
  v_mul_f32 v101, v124, v101
  v_mul_f32 v86, v120, v86
  v_mul_f32 v102, v124, v102
  v_mul_f32 v87, v120, v87
  v_mul_f32 v103, v124, v103
  v_cvt_pk_bf16_f32 v104, v72, v73
  v_cvt_pk_bf16_f32 v112, v88, v89
  v_cvt_pk_bf16_f32 v105, v74, v75
  v_cvt_pk_bf16_f32 v113, v90, v91
  v_cvt_pk_bf16_f32 v106, v76, v77
  v_cvt_pk_bf16_f32 v114, v92, v93
  v_cvt_pk_bf16_f32 v107, v78, v79
  v_cvt_pk_bf16_f32 v115, v94, v95
  v_cvt_pk_bf16_f32 v108, v80, v81
  v_cvt_pk_bf16_f32 v116, v96, v97
  v_cvt_pk_bf16_f32 v109, v82, v83
  v_cvt_pk_bf16_f32 v117, v98, v99
  v_cvt_pk_bf16_f32 v110, v84, v85
  v_cvt_pk_bf16_f32 v118, v100, v101
  v_cvt_pk_bf16_f32 v111, v86, v87
  v_cvt_pk_bf16_f32 v119, v102, v103
  s_add_u32 m0, s41, 57344
  s_add_u32 s38, s46, 200704
  buffer_load_dwordx4 v1, s[16:19], s38 offen lds
  s_add_u32 m0, s41, 61440
  s_add_u32 s38, s46, 215040
  buffer_load_dwordx4 v1, s[16:19], s38 offen lds
  s_add_u32 m0, s41, 65536
  s_add_u32 s38, s46, 229376
  buffer_load_dwordx4 v1, s[16:19], s38 offen lds
  s_add_u32 m0, s41, 69632
  s_add_u32 s38, s46, 243712
  buffer_load_dwordx4 v1, s[16:19], s38 offen lds
  s_add_u32 m0, s41, 73728
  s_add_u32 s38, s46, 258048
  buffer_load_dwordx4 v1, s[16:19], s38 offen lds
  s_add_u32 m0, s41, 77824
  s_add_u32 s38, s46, 272384
  buffer_load_dwordx4 v1, s[16:19], s38 offen lds
  v_and_b32 v12, 7, v0
  v_lshlrev_b32 v12, 5, v12
  s_and_b32 s38, s2, 31
  v_add_u32 v12, s38, v12
  v_lshlrev_b32 v4, 7, v12
  s_mov_b32 s38, 196608
  buffer_load_dword v5, v4, s[24:27], s38 offen sc1
  s_lshl_b32 s38, s35, 12
  s_add_u32 s40, s38, s66
  s_mov_b32 s67, 0
L1b_poll_10:
  buffer_load_dwordx4 v[32:35], v9, s[24:27], s40 offen offset:0 sc1
  buffer_load_dwordx4 v[36:39], v9, s[24:27], s40 offen offset:1024 sc1
  buffer_load_dwordx4 v[40:43], v9, s[24:27], s40 offen offset:2048 sc1
  buffer_load_dwordx4 v[44:47], v9, s[24:27], s40 offen offset:3072 sc1
  s_waitcnt vmcnt(0)
  v_max3_u32 v10, v32, v33, v34
  v_max3_u32 v10, v10, v35, v36
  v_max3_u32 v10, v10, v37, v38
  v_max3_u32 v10, v10, v39, v40
  v_max3_u32 v10, v10, v41, v42
  v_max3_u32 v10, v10, v43, v44
  v_max3_u32 v10, v10, v45, v46
  v_max_u32 v10, v10, v47
  v_cmp_eq_u32 vcc, -1, v10
  s_cbranch_vccz L1b_done_11
  s_add_u32 s67, s67, 1
  s_cmp_lt_u32 s67, 20000
  s_cbranch_scc1 L1b_poll_10
L1b_done_11:
  v_mfma_f32_32x32x16_bf16 v[16:31], v[32:35], v[104:107], 0
  v_mfma_f32_32x32x16_bf16 v[16:31], v[36:39], v[108:111], v[16:31]
  v_mfma_f32_32x32x16_bf16 v[16:31], v[40:43], v[112:115], v[16:31]
  v_mfma_f32_32x32x16_bf16 v[16:31], v[44:47], v[116:119], v[16:31]
  s_nop 15
  v_mov_b32 v10, v28
  v_mov_b32 v11, v28
  s_nop 1
  v_permlane32_swap_b32 v10, v11
  v_add_f32 v11, 0x358637bd, v11
  v_rcp_f32 v12, v11
  s_nop 0
  v_mul_f32 v16, v12, v16
  v_mul_f32 v17, v12, v17
  v_mul_f32 v18, v12, v18
  v_mul_f32 v19, v12, v19
  v_mul_f32 v20, v12, v20
  v_mul_f32 v21, v12, v21
  v_mul_f32 v22, v12, v22
  v_mul_f32 v23, v12, v23
  v_mul_f32 v24, v12, v24
  v_mul_f32 v25, v12, v25
  v_mul_f32 v26, v12, v26
  v_mul_f32 v27, v12, v27
  v_mul_f32 v28, v12, v28
  v_mul_f32 v29, v12, v29
  v_mul_f32 v30, v12, v30
  v_mul_f32 v31, v12, v31
  v_cvt_pk_bf16_f32 v48, v16, v17
  v_cvt_pk_bf16_f32 v49, v18, v19
  v_cvt_pk_bf16_f32 v50, v20, v21
  v_cvt_pk_bf16_f32 v51, v22, v23
  v_cvt_pk_bf16_f32 v52, v24, v25
  v_cvt_pk_bf16_f32 v53, v26, v27
  v_cvt_pk_bf16_f32 v54, v28, v29
  v_cvt_pk_bf16_f32 v55, v30, v31
  v_cndmask_b32 v54, v54, v15, s[58:59]
  v_cndmask_b32 v55, v55, v15, s[58:59]
  buffer_store_dwordx4 v[48:51], v9, s[24:27], s65 offen sc1
  buffer_store_dwordx4 v[52:55], v9, s[24:27], s65 offen offset:1024 sc1
  s_lshl_b32 s38, s36, 1
  s_lshr_b32 s39, s37, 2
  s_add_u32 s38, s38, s39
  s_mov_b32 s44, s38
  s_lshl_b32 s38, s38, 15
  s_lshl_b32 s39, s33, 13
  s_add_u32 s38, s38, s39
  s_add_u32 s40, s38, 3211264
  s_barrier
  s_cmp_eq_u32 s43, 0
  s_cbranch_scc1 Lwo2_12
  ds_read_b64_tr_b16 v[128:129], v2 offset:0
  ds_read_b64_tr_b16 v[130:131], v2 offset:2048
  ds_read_b64_tr_b16 v[132:133], v2 offset:4096
  ds_read_b64_tr_b16 v[134:135], v2 offset:6144
  ds_read_b64_tr_b16 v[136:137], v2 offset:7168
  ds_read_b64_tr_b16 v[138:139], v2 offset:9216
  ds_read_b64_tr_b16 v[140:141], v2 offset:11264
  ds_read_b64_tr_b16 v[142:143], v2 offset:13312
  ds_read_b64_tr_b16 v[144:145], v2 offset:14336
  ds_read_b64_tr_b16 v[146:147], v2 offset:16384
  ds_read_b64_tr_b16 v[148:149], v2 offset:18432
  ds_read_b64_tr_b16 v[150:151], v2 offset:20480
  ds_read_b64_tr_b16 v[152:153], v2 offset:21504
  ds_read_b64_tr_b16 v[154:155], v2 offset:23552
  ds_read_b64_tr_b16 v[156:157], v2 offset:25600
  ds_read_b64_tr_b16 v[158:159], v2 offset:27648
  ds_read_b64_tr_b16 v[160:161], v2 offset:28672
  ds_read_b64_tr_b16 v[162:163], v2 offset:30720
  ds_read_b64_tr_b16 v[164:165], v2 offset:32768
  ds_read_b64_tr_b16 v[166:167], v2 offset:34816
  ds_read_b64_tr_b16 v[168:169], v2 offset:35840
  ds_read_b64_tr_b16 v[170:171], v2 offset:37888
  ds_read_b64_tr_b16 v[172:173], v2 offset:39936
  ds_read_b64_tr_b16 v[174:175], v2 offset:41984
  ds_read_b64_tr_b16 v[176:177], v2 offset:43008
  ds_read_b64_tr_b16 v[178:179], v2 offset:45056
  ds_read_b64_tr_b16 v[180:181], v2 offset:47104
  ds_read_b64_tr_b16 v[182:183], v2 offset:49152
  ds_read_b64_tr_b16 v[184:185], v2 offset:50176
  ds_read_b64_tr_b16 v[186:187], v2 offset:52224
  ds_read_b64_tr_b16 v[188:189], v2 offset:54272
  ds_read_b64_tr_b16 v[190:191], v2 offset:56320
  ds_read_b64_tr_b16 v[192:193], v2 offset:57344
  ds_read_b64_tr_b16 v[194:195], v2 offset:59392
  ds_read_b64_tr_b16 v[196:197], v2 offset:61440
  ds_read_b64_tr_b16 v[198:199], v2 offset:63488
  ds_read_b64_tr_b16 v[200:201], v6 offset:31744
  ds_read_b64_tr_b16 v[202:203], v6 offset:33792
  ds_read_b64_tr_b16 v[204:205], v6 offset:35840
  ds_read_b64_tr_b16 v[206:207], v6 offset:37888
  ds_read_b64_tr_b16 v[208:209], v6 offset:38912
  ds_read_b64_tr_b16 v[210:211], v6 offset:40960
  ds_read_b64_tr_b16 v[212:213], v6 offset:43008
  ds_read_b64_tr_b16 v[214:215], v6 offset:45056
Lwo2_12:
  s_waitcnt lgkmcnt(0)
  s_barrier
  s_add_u32 m0, s41, 0
  s_add_u32 s38, s46, 275968
  buffer_load_dwordx4 v1, s[16:19], s38 offen lds
  s_add_u32 m0, s41, 4096
  s_add_u32 s38, s46, 290304
  buffer_load_dwordx4 v1, s[16:19], s38 offen lds
  s_add_u32 m0, s41, 8192
  s_add_u32 s38, s46, 304640
  buffer_load_dwordx4 v1, s[16:19], s38 offen lds
  s_add_u32 m0, s41, 12288
  s_add_u32 s38, s46, 318976
  buffer_load_dwordx4 v1, s[16:19], s38 offen lds
  s_add_u32 m0, s41, 16384
  s_add_u32 s38, s46, 333312
  buffer_load_dwordx4 v1, s[16:19], s38 offen lds
  s_add_u32 m0, s41, 20480
  s_add_u32 s38, s46, 347648
  buffer_load_dwordx4 v1, s[16:19], s38 offen lds
  s_add_u32 m0, s41, 24576
  s_add_u32 s38, s46, 361984
  buffer_load_dwordx4 v1, s[16:19], s38 offen lds
  s_add_u32 m0, s41, 28672
  s_add_u32 s38, s46, 376320
  buffer_load_dwordx4 v1, s[16:19], s38 offen lds
  s_add_u32 m0, s41, 32768
  s_add_u32 s38, s46, 390656
  buffer_load_dwordx4 v1, s[16:19], s38 offen lds
  s_waitcnt vmcnt(9)
  s_mov_b32 s67, 0
  s_mov_b32 s38, 196608
Lcfp_14:
  v_cmp_ne_u32 vcc, s32, v5
  s_cbranch_vccz Lcf_13
  s_sleep 4
  buffer_load_dword v5, v4, s[24:27], s38 offen sc1
  s_waitcnt vmcnt(0)
  s_add_u32 s67, s67, 1
  s_cmp_lt_u32 s67, 20000
  s_cbranch_scc1 Lcfp_14
Lcf_13:
  s_add_u32 s38, s40, 0
  buffer_load_dwordx4 v[72:75], v9, s[24:27], s38 offen offset:0 sc1
  s_add_u32 s38, s40, 0
  buffer_load_dwordx4 v[76:79], v9, s[24:27], s38 offen offset:1024 sc1
  s_add_u32 s38, s40, 0
  buffer_load_dwordx4 v[80:83], v9, s[24:27], s38 offen offset:2048 sc1
  s_add_u32 s38, s40, 0
  buffer_load_dwordx4 v[84:87], v9, s[24:27], s38 offen offset:3072 sc1
  s_add_u32 s38, s40, 4096
  buffer_load_dwordx4 v[88:91], v9, s[24:27], s38 offen offset:0 sc1
  s_add_u32 s38, s40, 4096
  buffer_load_dwordx4 v[92:95], v9, s[24:27], s38 offen offset:1024 sc1
  s_add_u32 s38, s40, 4096
  buffer_load_dwordx4 v[96:99], v9, s[24:27], s38 offen offset:2048 sc1
  s_add_u32 s38, s40, 4096
  buffer_load_dwordx4 v[100:103], v9, s[24:27], s38 offen offset:3072 sc1
  s_lshl_b32 s38, s33, 13
  s_add_u32 s38, s38, 36864
  v_add_u32 v7, s38, v9
  v_add_u32 v8, 36864, v9
  s_mov_b32 s67, 0
Lh2_poll_15:
  s_waitcnt vmcnt(0)
  v_max3_u32 v10, v72, v73, v74
  v_max3_u32 v10, v10, v75, v76
  v_max3_u32 v10, v10, v77, v78
  v_max3_u32 v10, v10, v79, v80
  v_max3_u32 v10, v10, v81, v82
  v_max3_u32 v10, v10, v83, v84
  v_max3_u32 v10, v10, v85, v86
  v_max3_u32 v10, v10, v87, v88
  v_max3_u32 v10, v10, v89, v90
  v_max3_u32 v10, v10, v91, v92
  v_max3_u32 v10, v10, v93, v94
  v_max3_u32 v10, v10, v95, v96
  v_max3_u32 v10, v10, v97, v98
  v_max3_u32 v10, v10, v99, v100
  v_max3_u32 v10, v10, v101, v102
  v_max_u32 v10, v10, v103
  v_cmp_eq_u32 vcc, -1, v10
  s_cbranch_vccz Lh2_done_16
  s_add_u32 s38, s40, 0
  buffer_load_dwordx4 v[72:75], v9, s[24:27], s38 offen offset:0 sc1
  s_add_u32 s38, s40, 0
  buffer_load_dwordx4 v[76:79], v9, s[24:27], s38 offen offset:1024 sc1
  s_add_u32 s38, s40, 0
  buffer_load_dwordx4 v[80:83], v9, s[24:27], s38 offen offset:2048 sc1
  s_add_u32 s38, s40, 0
  buffer_load_dwordx4 v[84:87], v9, s[24:27], s38 offen offset:3072 sc1
  s_add_u32 s38, s40, 4096
  buffer_load_dwordx4 v[88:91], v9, s[24:27], s38 offen offset:0 sc1
  s_add_u32 s38, s40, 4096
  buffer_load_dwordx4 v[92:95], v9, s[24:27], s38 offen offset:1024 sc1
  s_add_u32 s38, s40, 4096
  buffer_load_dwordx4 v[96:99], v9, s[24:27], s38 offen offset:2048 sc1
  s_add_u32 s38, s40, 4096
  buffer_load_dwordx4 v[100:103], v9, s[24:27], s38 offen offset:3072 sc1
  s_add_u32 s67, s67, 1
  s_cmp_lt_u32 s67, 20000
  s_cbranch_scc1 Lh2_poll_15
  s_waitcnt vmcnt(0)
Lh2_done_16:
  ds_write_b128 v7, v[72:75] offset:0
  ds_write_b128 v7, v[76:79] offset:1024
  ds_write_b128 v7, v[80:83] offset:2048
  ds_write_b128 v7, v[84:87] offset:3072
  ds_write_b128 v7, v[88:91] offset:4096
  ds_write_b128 v7, v[92:95] offset:5120
  ds_write_b128 v7, v[96:99] offset:6144
  ds_write_b128 v7, v[100:103] offset:7168
  s_waitcnt lgkmcnt(0)
  s_barrier
  s_cmp_eq_u32 s43, 0
  s_cbranch_scc1 LB_epoch_18
  ds_read_b64_tr_b16 v[216:217], v2 offset:0
  ds_read_b64_tr_b16 v[218:219], v2 offset:2048
  ds_read_b64_tr_b16 v[220:221], v2 offset:4096
  ds_read_b64_tr_b16 v[222:223], v2 offset:6144
  ds_read_b64_tr_b16 v[224:225], v2 offset:7168
  ds_read_b64_tr_b16 v[226:227], v2 offset:9216
  ds_read_b64_tr_b16 v[228:229], v2 offset:11264
  ds_read_b64_tr_b16 v[230:231], v2 offset:13312
  ds_read_b64_tr_b16 v[232:233], v2 offset:14336
  ds_read_b64_tr_b16 v[234:235], v2 offset:16384
  ds_read_b64_tr_b16 v[236:237], v2 offset:18432
  ds_read_b64_tr_b16 v[238:239], v2 offset:20480
  ds_read_b64_tr_b16 v[240:241], v2 offset:21504
  ds_read_b64_tr_b16 v[242:243], v2 offset:23552
  ds_read_b64_tr_b16 v[244:245], v2 offset:25600
  ds_read_b64_tr_b16 v[246:247], v2 offset:27648
  ds_read_b64_tr_b16 v[248:249], v2 offset:28672
  ds_read_b64_tr_b16 v[250:251], v2 offset:30720
  ds_read_b64_tr_b16 v[252:253], v2 offset:32768
  ds_read_b64_tr_b16 v[254:255], v2 offset:34816
  ds_read_b128 v[32:35], v8 offset:0
  ds_read_b128 v[36:39], v8 offset:1024
  ds_read_b128 v[40:43], v8 offset:2048
  ds_read_b128 v[44:47], v8 offset:3072
  ds_read_b128 v[48:51], v8 offset:4096
  ds_read_b128 v[52:55], v8 offset:5120
  ds_read_b128 v[56:59], v8 offset:6144
  ds_read_b128 v[60:63], v8 offset:7168
  s_waitcnt lgkmcnt(7)
  v_mfma_f32_32x32x16_bf16 v[16:31], v[128:131], v[32:35], 0
  s_waitcnt lgkmcnt(6)
  v_mfma_f32_32x32x16_bf16 v[16:31], v[132:135], v[36:39], v[16:31]
  s_waitcnt lgkmcnt(5)
  v_mfma_f32_32x32x16_bf16 v[16:31], v[136:139], v[40:43], v[16:31]
  s_waitcnt lgkmcnt(4)
  v_mfma_f32_32x32x16_bf16 v[16:31], v[140:143], v[44:47], v[16:31]
  ds_read_b128 v[32:35], v8 offset:8192
  ds_read_b128 v[36:39], v8 offset:9216
  ds_read_b128 v[40:43], v8 offset:10240
  ds_read_b128 v[44:47], v8 offset:11264
  s_waitcnt lgkmcnt(7)
  v_mfma_f32_32x32x16_bf16 v[16:31], v[144:147], v[48:51], v[16:31]
  s_waitcnt lgkmcnt(6)
  v_mfma_f32_32x32x16_bf16 v[16:31], v[148:151], v[52:55], v[16:31]
  s_waitcnt lgkmcnt(5)
  v_mfma_f32_32x32x16_bf16 v[16:31], v[152:155], v[56:59], v[16:31]
  s_waitcnt lgkmcnt(4)
  v_mfma_f32_32x32x16_bf16 v[16:31], v[156:159], v[60:63], v[16:31]
  ds_read_b128 v[48:51], v8 offset:12288
  ds_read_b128 v[52:55], v8 offset:13312
  ds_read_b128 v[56:59], v8 offset:14336
  ds_read_b128 v[60:63], v8 offset:15360
  s_waitcnt lgkmcnt(7)
  v_mfma_f32_32x32x16_bf16 v[16:31], v[160:163], v[32:35], v[16:31]
  s_waitcnt lgkmcnt(6)
  v_mfma_f32_32x32x16_bf16 v[16:31], v[164:167], v[36:39], v[16:31]
  s_waitcnt lgkmcnt(5)
  v_mfma_f32_32x32x16_bf16 v[16:31], v[168:171], v[40:43], v[16:31]
  s_waitcnt lgkmcnt(4)
  v_mfma_f32_32x32x16_bf16 v[16:31], v[172:175], v[44:47], v[16:31]
  ds_read_b128 v[32:35], v8 offset:16384
  ds_read_b128 v[36:39], v8 offset:17408
  ds_read_b128 v[40:43], v8 offset:18432
  ds_read_b128 v[44:47], v8 offset:19456
  s_waitcnt lgkmcnt(7)
  v_mfma_f32_32x32x16_bf16 v[16:31], v[176:179], v[48:51], v[16:31]
  s_waitcnt lgkmcnt(6)
  v_mfma_f32_32x32x16_bf16 v[16:31], v[180:183], v[52:55], v[16:31]
  s_waitcnt lgkmcnt(5)
  v_mfma_f32_32x32x16_bf16 v[16:31], v[184:187], v[56:59], v[16:31]
  s_waitcnt lgkmcnt(4)
  v_mfma_f32_32x32x16_bf16 v[16:31], v[188:191], v[60:63], v[16:31]
  ds_read_b128 v[48:51], v8 offset:20480
  ds_read_b128 v[52:55], v8 offset:21504
  ds_read_b128 v[56:59], v8 offset:22528
  ds_read_b128 v[60:63], v8 offset:23552
  s_waitcnt lgkmcnt(7)
  v_mfma_f32_32x32x16_bf16 v[16:31], v[192:195], v[32:35], v[16:31]
  s_waitcnt lgkmcnt(6)
  v_mfma_f32_32x32x16_bf16 v[16:31], v[196:199], v[36:39], v[16:31]
  s_waitcnt lgkmcnt(5)
  v_mfma_f32_32x32x16_bf16 v[16:31], v[200:203], v[40:43], v[16:31]
  s_waitcnt lgkmcnt(4)
  v_mfma_f32_32x32x16_bf16 v[16:31], v[204:207], v[44:47], v[16:31]
  ds_read_b128 v[32:35], v8 offset:24576
  ds_read_b128 v[36:39], v8 offset:25600
  ds_read_b128 v[40:43], v8 offset:26624
  ds_read_b128 v[44:47], v8 offset:27648
  s_waitcnt lgkmcnt(7)
  v_mfma_f32_32x32x16_bf16 v[16:31], v[208:211], v[48:51], v[16:31]
  s_waitcnt lgkmcnt(6)
  v_mfma_f32_32x32x16_bf16 v[16:31], v[212:215], v[52:55], v[16:31]
  s_waitcnt lgkmcnt(5)
  v_mfma_f32_32x32x16_bf16 v[16:31], v[216:219], v[56:59], v[16:31]
  s_waitcnt lgkmcnt(4)
  v_mfma_f32_32x32x16_bf16 v[16:31], v[220:223], v[60:63], v[16:31]
  ds_read_b128 v[48:51], v8 offset:28672
  ds_read_b128 v[52:55], v8 offset:29696
  ds_read_b128 v[56:59], v8 offset:30720
  ds_read_b128 v[60:63], v8 offset:31744
  s_waitcnt lgkmcnt(7)
  v_mfma_f32_32x32x16_bf16 v[16:31], v[224:227], v[32:35], v[16:31]
  s_waitcnt lgkmcnt(6)
  v_mfma_f32_32x32x16_bf16 v[16:31], v[228:231], v[36:39], v[16:31]
  s_waitcnt lgkmcnt(5)
  v_mfma_f32_32x32x16_bf16 v[16:31], v[232:235], v[40:43], v[16:31]
  s_waitcnt lgkmcnt(4)
  v_mfma_f32_32x32x16_bf16 v[16:31], v[236:239], v[44:47], v[16:31]
  s_waitcnt lgkmcnt(3)
  v_mfma_f32_32x32x16_bf16 v[16:31], v[240:243], v[48:51], v[16:31]
  s_waitcnt lgkmcnt(2)
  v_mfma_f32_32x32x16_bf16 v[16:31], v[244:247], v[52:55], v[16:31]
  s_waitcnt lgkmcnt(1)
  v_mfma_f32_32x32x16_bf16 v[16:31], v[248:251], v[56:59], v[16:31]
  s_waitcnt lgkmcnt(0)
  v_mfma_f32_32x32x16_bf16 v[16:31], v[252:255], v[60:63], v[16:31]
  v_and_b32 v10, 31, v0
  v_mul_u32_u24 v10, 272, v10
  v_lshrrev_b32 v11, 5, v0
  v_lshlrev_b32 v11, 4, v11
  v_add_u32 v10, v10, v11
  s_lshl_b32 s38, s33, 6
  s_add_u32 s38, s38, 69632
  v_add_u32 v10, s38, v10
  s_nop 5
  v_cvt_pk_bf16_f32 v64, v16, v17
  v_cvt_pk_bf16_f32 v65, v18, v19
  v_cvt_pk_bf16_f32 v66, v20, v21
  v_cvt_pk_bf16_f32 v67, v22, v23
  v_cvt_pk_bf16_f32 v68, v24, v25
  v_cvt_pk_bf16_f32 v69, v26, v27
  v_cvt_pk_bf16_f32 v70, v28, v29
  v_cvt_pk_bf16_f32 v71, v30, v31
  s_nop 1
  v_permlane32_swap_b32 v64, v66
  v_permlane32_swap_b32 v65, v67
  v_permlane32_swap_b32 v68, v70
  v_permlane32_swap_b32 v69, v71
  s_nop 0
  ds_write_b128 v10, v[64:67]
  ds_write_b128 v10, v[68:71] offset:32
  s_branch LB_s3skip_17
LB_epoch_18:
  s_cmp_lg_u32 s37, 3
  s_cbranch_scc1 LB_s3skip_17
  s_cmp_lg_u32 s36, 0
  s_cbranch_scc1 LB_s3skip_17
  s_cmp_lg_u32 s33, 3
  s_cbranch_scc1 LB_s3skip_17
  v_lshlrev_b32 v10, 7, v0
  v_min_u32 v11, 31, v0
  v_lshlrev_b32 v11, 7, v11
  s_mov_b32 s67, 0
Lepl_19:
  s_mov_b32 s38, 65536
  buffer_load_dword v64, v10, s[24:27], s38 offen sc1
  s_mov_b32 s38, 73728
  buffer_load_dword v65, v10, s[24:27], s38 offen sc1
  s_mov_b32 s38, 81920
  buffer_load_dword v66, v10, s[24:27], s38 offen sc1
  s_mov_b32 s38, 90112
  buffer_load_dword v67, v11, s[24:27], s38 offen sc1
  s_waitcnt vmcnt(0)
  v_xor_b32 v64, s32, v64
  v_xor_b32 v65, s32, v65
  v_xor_b32 v66, s32, v66
  v_xor_b32 v67, s32, v67
  v_or3_b32 v64, v64, v65, v66
  v_or_b32 v64, v64, v67
  v_cmp_ne_u32 vcc, 0, v64
  s_cbranch_vccz Lepd_20
  s_add_u32 s67, s67, 1
  s_cmp_lt_u32 s67, 20000
  s_cbranch_scc1 Lepl_19
Lepd_20:
  s_mov_b64 exec, 0xff
  v_mov_b32 v64, s32
  v_mov_b32 v65, s32
  v_mov_b32 v66, s32
  v_mov_b32 v67, s32
  s_mov_b32 s38, 0
  buffer_store_dwordx4 v[64:67], v9, s[24:27], s38 offen sc1
  s_mov_b64 exec, -1
  s_nop 1
LB_s3skip_17:
  v_lshrrev_b32 v10, 4, v0
  s_lshl_b32 s38, s33, 3
  v_add_u32 v10, s38, v10
  v_and_b32 v11, 15, v0
  v_lshlrev_b32 v11, 4, v11
  v_mul_u32_u24 v12, 272, v10
  v_add_u32 v12, v12, v11
  v_add_u32 v12, 69632, v12
  s_lshl_b32 s38, s44, 5
  v_add_u32 v10, s38, v10
  v_mul_u32_u24 v10, 1792, v10
  v_add_u32 v10, v10, v11
  s_add_u32 s38, s45, 896
  s_waitcnt lgkmcnt(0)
  s_barrier
  ds_read_b128 v[64:67], v12
  ds_read_b128 v[68:71], v12 offset:1088
  s_cmp_lg_u32 s45, 768
  s_cbranch_scc1 Lmask_21
  s_mov_b32 exec_lo, 0x00ff00ff
  s_mov_b32 exec_hi, 0x00ff00ff
Lmask_21:
  s_waitcnt lgkmcnt(0)
  buffer_store_dwordx4 v[64:67], v10, s[28:31], s38 offen sc1
  s_add_u32 s38, s38, 7168
  buffer_store_dwordx4 v[68:71], v10, s[28:31], s38 offen sc1
  s_mov_b64 exec, -1
  s_endpgm
L_A:
  s_setprio 3
  s_load_dwordx16 s[40:55], s[0:1], 0
  s_load_dwordx2 s[56:57], s[0:1], 64
  s_load_dwordx2 s[58:59], s[0:1], 104
  s_load_dwordx2 s[60:61], s[0:1], 120
  v_lshrrev_b32 v1, 6, v0
  v_and_b32 v0, 63, v0
  s_nop 0
  v_readfirstlane_b32 s23, v1
  s_mov_b32 s22, s2
  s_lshr_b32 s20, s22, 5
  s_and_b32 s21, s22, 31
  v_lshlrev_b32 v9, 4, v0
  v_lshrrev_b32 v2, 3, v0
  v_and_b32 v3, 7, v0
  v_lshlrev_b32 v3, 4, v3
  s_lshr_b32 s24, s23, 1
  s_and_b32 s25, s23, 1
  s_lshl_b32 s28, s23, 11
  s_lshl_b32 s26, s23, 4
  v_add_u32 v2, s26, v2
  v_mul_u32_u24 v4, 896, v2
  v_add_u32 v4, v4, v3
  v_lshlrev_b32 v5, 7, v2
  v_add_u32 v5, v5, v3
  s_mul_i32 s31, s21, 57344
  s_lshl_b32 s26, s20, 7
  s_add_u32 s31, s31, s26
  s_lshl_b32 s26, s22, 1
  s_add_u32 s26, s26, s24
  s_lshl_b32 s26, s26, 9
  s_lshl_b32 s27, s25, 8
  s_add_u32 s26, s26, s27
  v_lshlrev_b32 v6, 2, v0
  v_add_u32 v6, s26, v6
  s_waitcnt lgkmcnt(0)
  s_mov_b32 s8, s40
  s_and_b32 s9, s41, 0xffff
  s_mov_b32 s10, 1835008
  s_mov_b32 s11, 0x20000
  s_add_u32 m0, s28, 0
  s_add_u32 s26, s31, 0
  buffer_load_dwordx4 v4, s[8:11], s26 offen lds
  s_add_u32 m0, s28, 1024
  s_add_u32 s26, s31, 7168
  buffer_load_dwordx4 v4, s[8:11], s26 offen lds
  s_lshl_b32 s26, s22, 10
  v_add_u32 v6, s26, v9
  s_cmp_lg_u32 s23, 0
  s_cbranch_scc1 Lpar_22
  s_mov_b32 m0, 17408
  s_nop 0
  global_load_lds_dwordx4 v6, s[42:43]
  s_mov_b32 m0, 21504
  s_nop 0
  global_load_lds_dwordx4 v6, s[50:51]
  s_branch Lpar_26
Lpar_22:
  s_cmp_lg_u32 s23, 1
  s_cbranch_scc1 Lpar_23
  s_mov_b32 m0, 18432
  s_nop 0
  global_load_lds_dwordx4 v6, s[44:45]
  s_mov_b32 m0, 22528
  s_nop 0
  global_load_lds_dwordx4 v6, s[52:53]
  s_branch Lpar_26
Lpar_23:
  s_cmp_lg_u32 s23, 2
  s_cbranch_scc1 Lpar_24
  s_mov_b32 m0, 19456
  s_nop 0
  global_load_lds_dwordx4 v6, s[46:47]
  s_branch Lpar_26
Lpar_24:
  s_cmp_lg_u32 s23, 3
  s_cbranch_scc1 Lpar_25
  s_mov_b32 m0, 20480
  s_nop 0
  global_load_lds_dwordx4 v6, s[48:49]
  s_branch Lpar_26
Lpar_25:
Lpar_26:
  s_mov_b32 s12, s60
  s_and_b32 s13, s61, 0xffff
  s_mov_b32 s14, 12582912
  s_mov_b32 s15, 0x20000
  s_mov_b32 s16, s58
  s_and_b32 s17, s59, 0xffff
  s_mov_b32 s18, 3670016
  s_mov_b32 s19, 0x20000
  s_load_dword s32, s[60:61], 0
  s_lshl_b32 s26, s22, 2
  s_add_u32 s54, s54, s26
  s_addc_u32 s55, s55, 0
  s_load_dword s30, s[54:55], 0
  v_mov_b32 v10, -1
  v_mov_b32 v11, -1
  v_mov_b32 v12, -1
  v_mov_b32 v13, -1
  s_mov_b32 s34, s22
  v_lshrrev_b32 v7, 4, v0
  v_lshlrev_b32 v7, 3, v7
  v_bfe_u32 v8, v0, 2, 2
  v_add_u32 v7, v7, v8
  v_lshlrev_b32 v7, 7, v7
  v_and_b32 v8, 3, v0
  v_lshlrev_b32 v8, 3, v8
  v_add_u32 v7, v7, v8
  s_lshl_b32 s26, s23, 5
  v_add_u32 v7, s26, v7
  v_and_b32 v8, 15, v0
  s_lshl_b32 s26, s23, 4
  v_add_u32 v8, s26, v8
  v_mul_u32_u24 v8, 144, v8
  v_lshrrev_b32 v14, 4, v0
  v_lshlrev_b32 v14, 4, v14
  v_add_u32 v8, v8, v14
  v_mul_u32_u24 v14, 144, v2
  v_add_u32 v14, v14, v3
  s_mul_i32 s63, s22, 8448
  s_mul_i32 s26, s23, 16880
  v_lshlrev_b32 v57, 3, v0
  v_add_u32 v57, s26, v57
  v_and_b32 v58, 31, v0
  v_mul_u32_u24 v58, 528, v58
  v_lshrrev_b32 v59, 5, v0
  v_lshlrev_b32 v59, 4, v59
  v_add_u32 v58, v58, v59
  v_add_u32 v58, s26, v58
  v_mul_u32_u24 v1, 2624, v0
  v_add_u32 v1, 79272, v1
  v_mov_b32 v14, 0
  s_mov_b64 exec, 3
  ds_write_b32 v1, v14
  s_mov_b64 exec, -1
  v_mul_u32_u24 v14, 144, v2
  v_add_u32 v14, v14, v3
  s_waitcnt vmcnt(0)
  s_barrier
  s_lshl_b32 s26, s24, 9
  s_lshl_b32 s27, s25, 8
  s_add_u32 s26, s26, s27
  v_lshlrev_b32 v6, 2, v0
  v_add_u32 v6, s26, v6
  ds_read_b32 v32, v6 offset:17408
  ds_read_b32 v33, v6 offset:18432
  ds_read_b32 v34, v6 offset:19456
  ds_read_b32 v35, v6 offset:20480
  ds_read_b32 v36, v6 offset:21504
  ds_read_b32 v37, v6 offset:22528
  v_and_b32 v1, 15, v0
  s_lshl_b32 s26, s23, 4
  v_add_u32 v1, s26, v1
  v_lshrrev_b32 v62, 4, v0
  v_lshlrev_b32 v62, 4, v62
  v_lshl_add_u32 v1, v1, 7, v62
  ds_read_b128 v[184:187], v1 offset:0
  ds_read_b128 v[188:191], v1 offset:64
  ds_read_b64_tr_b16 v[64:65], v7 offset:0
  ds_read_b64_tr_b16 v[66:67], v7 offset:512
  ds_read_b64_tr_b16 v[68:69], v7 offset:4096
  ds_read_b64_tr_b16 v[70:71], v7 offset:4608
  s_waitcnt lgkmcnt(0)
  ds_write_b128 v8, v[64:67] offset:8192
  ds_write_b128 v8, v[68:71] offset:8256
  ds_read_b128 v[72:75], v14 offset:8192
  ds_read_b128 v[76:79], v14 offset:9344
  s_waitcnt lgkmcnt(0)
  s_add_u32 s26, s63, 6291456
  buffer_store_dwordx4 v[72:75], v5, s[12:15], s26 offen sc1
  s_add_u32 s26, s63, 6292480
  buffer_store_dwordx4 v[76:79], v5, s[12:15], s26 offen sc1
Lclr_27:
  s_and_b32 s35, s34, 7
  s_lshl_b32 s35, s35, 2
  s_lshr_b32 s36, s34, 3
  s_and_b32 s36, s36, 3
  s_add_u32 s35, s35, s36
  s_lshr_b32 s36, s34, 5
  s_lshl_b32 s37, s36, 5
  s_add_u32 s37, s37, s35
  s_mul_i32 s37, s37, 8448
  s_add_u32 s37, s37, s28
  s_add_u32 s37, s37, 1048576
  buffer_store_dwordx4 v[10:13], v9, s[12:15], s37 offen sc1
  buffer_store_dwordx4 v[10:13], v9, s[12:15], s37 offen offset:1024 sc1
  s_cmp_lg_u32 s23, 0
  s_cbranch_scc1 Lred_28
  s_lshl_b32 s37, s36, 13
  s_lshl_b32 s38, s35, 8
  s_add_u32 s37, s37, s38
  s_add_u32 s37, s37, 5308416
  s_mov_b64 exec, 0xffff
  buffer_store_dwordx4 v[10:13], v9, s[12:15], s37 offen sc1
  s_mov_b64 exec, -1
Lred_28:
  s_add_u32 s34, s34, 224
  s_cmp_lt_u32 s34, 256
  s_cbranch_scc1 Lclr_27
  s_getpc_b64 s[64:65]
L_pc:
  s_add_u32 s64, s64, L_tab-L_pc
  s_addc_u32 s65, s65, 0
  s_lshl_b32 s26, s23, 6
  v_add_u32 v1, s26, v0
  v_lshlrev_b32 v6, 4, v1
  v_lshlrev_b32 v1, 3, v1
  v_add_u32 v1, 4096, v1
  global_load_dwordx4 v[172:175], v6, s[64:65]
  global_load_dwordx2 v[176:177], v1, s[64:65]
  s_setprio 1
  s_lshl_b32 s26, s24, 4
  s_lshr_b32 s30, s30, s26
  s_lshl_b32 s30, s30, 16
  v_mov_b32 v14, s30
  v_mul_f32 v14, 0x3fb8aa3b, v14
  v_exp_f32 v14, v14
  s_nop 0
  v_cvt_pk_bf16_f32 v14, v14, v14
  v_lshlrev_b32 v15, 16, v14
  v_lshlrev_b32 v192, 16, v32
  v_lshlrev_b32 v193, 16, v33
  v_lshlrev_b32 v194, 16, v34
  v_lshlrev_b32 v195, 16, v35
  v_lshlrev_b32 v196, 16, v36
  v_lshlrev_b32 v197, 16, v37
  v_mul_f32 v192, v15, v192
  v_mul_f32 v193, v15, v193
  v_mul_f32 v194, v15, v194
  v_mul_f32 v195, v15, v195
  v_and_b32 v224, 0xffff0000, v32
  v_and_b32 v225, 0xffff0000, v33
  v_and_b32 v226, 0xffff0000, v34
  v_and_b32 v227, 0xffff0000, v35
  v_and_b32 v228, 0xffff0000, v36
  v_and_b32 v229, 0xffff0000, v37
  v_mul_f32 v224, v15, v224
  v_mul_f32 v225, v15, v225
  v_mul_f32 v226, v15, v226
  v_mul_f32 v227, v15, v227
  v_mul_f32 v60, v197, v195
  v_mul_f32 v61, v197, v194
  v_fma_f32 v198, v196, v194, -v60
  v_fma_f32 v199, -v196, v195, -v61
  v_mul_f32 v60, v229, v227
  v_mul_f32 v61, v229, v226
  v_fma_f32 v230, v228, v226, -v60
  v_fma_f32 v231, -v228, v227, -v61
  v_mul_f32 v60, 0x4138aa3b, v192
  v_mul_f32 v61, 0x3fa2f983, v193
  v_mul_f32 v62, 0x4138aa3b, v224
  v_mul_f32 v63, 0x3fa2f983, v225
  v_exp_f32 v60, v60
  v_fract_f32 v61, v61
  v_exp_f32 v62, v62
  v_fract_f32 v63, v63
  v_cos_f32 v202, v61
  v_sin_f32 v203, v61
  v_cos_f32 v234, v63
  v_sin_f32 v235, v63
  v_mul_f32 v202, v60, v202
  v_mul_f32 v203, v60, v203
  v_mul_f32 v234, v62, v234
  v_mul_f32 v235, v62, v235
  v_mul_f32 v60, 0x3fb8aa3b, v192
  v_mul_f32 v61, 0x3e22f983, v193
  v_mul_f32 v62, 0x3fb8aa3b, v224
  v_mul_f32 v63, 0x3e22f983, v225
  v_exp_f32 v60, v60
  v_fract_f32 v61, v61
  v_exp_f32 v62, v62
  v_fract_f32 v63, v63
  v_cos_f32 v200, v61
  v_sin_f32 v201, v61
  v_cos_f32 v232, v63
  v_sin_f32 v233, v63
  v_mul_f32 v200, v60, v200
  v_mul_f32_e64 v201, -v60, v201
  v_mul_f32 v232, v62, v232
  v_mul_f32_e64 v233, -v62, v233
  v_mul_f32 v60, 0x43b8aa3b, v192
  v_mul_f32 v61, 0x4222f983, v193
  v_mul_f32 v62, 0x43b8aa3b, v224
  v_mul_f32 v63, 0x4222f983, v225
  v_exp_f32 v60, v60
  v_fract_f32 v61, v61
  v_exp_f32 v62, v62
  v_fract_f32 v63, v63
  v_cos_f32 v204, v61
  v_sin_f32 v205, v61
  v_cos_f32 v236, v63
  v_sin_f32 v237, v63
  v_mul_f32 v204, v60, v204
  v_mul_f32_e64 v205, -v60, v205
  v_mul_f32 v236, v62, v236
  v_mul_f32_e64 v237, -v62, v237
  v_mul_f32 v222, v205, v205
  v_mul_f32 v207, v205, v204
  v_mul_f32 v254, v237, v237
  v_mul_f32 v239, v237, v236
  v_fmac_f32 v207, v204, v205
  v_fma_f32 v206, v204, v204, -v222
  v_fmac_f32 v239, v236, v237
  v_fma_f32 v238, v236, v236, -v254
  v_mul_f32 v222, v207, v207
  v_mul_f32 v209, v207, v206
  v_mul_f32 v254, v239, v239
  v_mul_f32 v241, v239, v238
  v_fmac_f32 v209, v206, v207
  v_fma_f32 v208, v206, v206, -v222
  v_fmac_f32 v241, v238, v239
  v_fma_f32 v240, v238, v238, -v254
  s_waitcnt vmcnt(0)
  s_barrier
  s_add_u32 s32, s32, 2654435769
  s_cmp_lg_u32 s23, 0
  s_cbranch_scc1 Lafs_29
  s_lshl_b32 s26, s22, 7
  s_add_u32 s26, s26, 65536
  v_mov_b32 v10, s32
  v_mov_b32 v11, s32
  v_mov_b32 v12, s32
  v_mov_b32 v13, s32
  s_mov_b64 exec, 0xff
  buffer_store_dwordx4 v[10:13], v9, s[12:15], s26 offen sc1
  s_mov_b64 exec, -1
  s_nop 1
Lafs_29:
  v_mov_b32 v54, 0x3f80
  v_mov_b32 v55, 0x3f80
  ds_write_b64 v57, v[54:55] offset:0
  v_cvt_pk_bf16_f32 v40, v202, v203
  v_cvt_pk_bf16_f32 v41, v234, v235
  ds_write_b64 v57, v[40:41] offset:528
  v_mul_f32 v222, v203, v203
  v_mul_f32 v211, v203, v202
  v_mul_f32 v254, v235, v235
  v_mul_f32 v243, v235, v234
  v_fmac_f32 v211, v202, v203
  v_fma_f32 v210, v202, v202, -v222
  v_fmac_f32 v243, v234, v235
  v_fma_f32 v242, v234, v234, -v254
  v_cvt_pk_bf16_f32 v42, v210, v211
  v_cvt_pk_bf16_f32 v43, v242, v243
  ds_write_b64 v57, v[42:43] offset:1056
  v_mul_f32 v222, v211, v203
  v_mul_f32 v211, v211, v202
  v_mul_f32 v254, v243, v235
  v_mul_f32 v243, v243, v234
  v_fmac_f32 v211, v210, v203
  v_fma_f32 v210, v210, v202, -v222
  v_fmac_f32 v243, v242, v235
  v_fma_f32 v242, v242, v234, -v254
  v_cvt_pk_bf16_f32 v44, v210, v211
  v_cvt_pk_bf16_f32 v45, v242, v243
  ds_write_b64 v57, v[44:45] offset:1584
  v_mul_f32 v222, v211, v203
  v_mul_f32 v211, v211, v202
  v_mul_f32 v254, v243, v235
  v_mul_f32 v243, v243, v234
  v_fmac_f32 v211, v210, v203
  v_fma_f32 v210, v210, v202, -v222
  v_fmac_f32 v243, v242, v235
  v_fma_f32 v242, v242, v234, -v254
  v_cvt_pk_bf16_f32 v46, v210, v211
  v_cvt_pk_bf16_f32 v47, v242, v243
  ds_write_b64 v57, v[46:47] offset:2112
  v_mul_f32 v222, v211, v203
  v_mul_f32 v211, v211, v202
  v_mul_f32 v254, v243, v235
  v_mul_f32 v243, v243, v234
  v_fmac_f32 v211, v210, v203
  v_fma_f32 v210, v210, v202, -v222
  v_fmac_f32 v243, v242, v235
  v_fma_f32 v242, v242, v234, -v254
  v_cvt_pk_bf16_f32 v48, v210, v211
  v_cvt_pk_bf16_f32 v49, v242, v243
  ds_write_b64 v57, v[48:49] offset:2640
  v_mul_f32 v222, v211, v203
  v_mul_f32 v211, v211, v202
  v_mul_f32 v254, v243, v235
  v_mul_f32 v243, v243, v234
  v_fmac_f32 v211, v210, v203
  v_fma_f32 v210, v210, v202, -v222
  v_fmac_f32 v243, v242, v235
  v_fma_f32 v242, v242, v234, -v254
  v_cvt_pk_bf16_f32 v50, v210, v211
  v_cvt_pk_bf16_f32 v51, v242, v243
  ds_write_b64 v57, v[50:51] offset:3168
  v_mul_f32 v222, v211, v203
  v_mul_f32 v211, v211, v202
  v_mul_f32 v254, v243, v235
  v_mul_f32 v243, v243, v234
  v_fmac_f32 v211, v210, v203
  v_fma_f32 v210, v210, v202, -v222
  v_fmac_f32 v243, v242, v235
  v_fma_f32 v242, v242, v234, -v254
  v_cvt_pk_bf16_f32 v52, v210, v211
  v_cvt_pk_bf16_f32 v53, v242, v243
  ds_write_b64 v57, v[52:53] offset:3696
  v_mul_f32 v222, v211, v203
  v_mul_f32 v211, v211, v202
  v_mul_f32 v254, v243, v235
  v_mul_f32 v243, v243, v234
  v_fmac_f32 v211, v210, v203
  v_fma_f32 v210, v210, v202, -v222
  v_fmac_f32 v243, v242, v235
  v_fma_f32 v242, v242, v234, -v254
  v_cvt_pk_bf16_f32 v54, v210, v211
  v_cvt_pk_bf16_f32 v55, v242, v243
  ds_write_b64 v57, v[54:55] offset:4224
  v_mul_f32 v222, v211, v203
  v_mul_f32 v211, v211, v202
  v_mul_f32 v254, v243, v235
  v_mul_f32 v243, v243, v234
  v_fmac_f32 v211, v210, v203
  v_fma_f32 v210, v210, v202, -v222
  v_fmac_f32 v243, v242, v235
  v_fma_f32 v242, v242, v234, -v254
  v_cvt_pk_bf16_f32 v40, v210, v211
  v_cvt_pk_bf16_f32 v41, v242, v243
  ds_write_b64 v57, v[40:41] offset:4752
  v_mul_f32 v222, v211, v203
  v_mul_f32 v211, v211, v202
  v_mul_f32 v254, v243, v235
  v_mul_f32 v243, v243, v234
  v_fmac_f32 v211, v210, v203
  v_fma_f32 v210, v210, v202, -v222
  v_fmac_f32 v243, v242, v235
  v_fma_f32 v242, v242, v234, -v254
  v_cvt_pk_bf16_f32 v42, v210, v211
  v_cvt_pk_bf16_f32 v43, v242, v243
  ds_write_b64 v57, v[42:43] offset:5280
  v_mul_f32 v222, v211, v203
  v_mul_f32 v211, v211, v202
  v_mul_f32 v254, v243, v235
  v_mul_f32 v243, v243, v234
  v_fmac_f32 v211, v210, v203
  v_fma_f32 v210, v210, v202, -v222
  v_fmac_f32 v243, v242, v235
  v_fma_f32 v242, v242, v234, -v254
  v_cvt_pk_bf16_f32 v44, v210, v211
  v_cvt_pk_bf16_f32 v45, v242, v243
  ds_write_b64 v57, v[44:45] offset:5808
  v_mul_f32 v222, v211, v203
  v_mul_f32 v211, v211, v202
  v_mul_f32 v254, v243, v235
  v_mul_f32 v243, v243, v234
  v_fmac_f32 v211, v210, v203
  v_fma_f32 v210, v210, v202, -v222
  v_fmac_f32 v243, v242, v235
  v_fma_f32 v242, v242, v234, -v254
  v_cvt_pk_bf16_f32 v46, v210, v211
  v_cvt_pk_bf16_f32 v47, v242, v243
  ds_write_b64 v57, v[46:47] offset:6336
  v_mul_f32 v222, v211, v203
  v_mul_f32 v211, v211, v202
  v_mul_f32 v254, v243, v235
  v_mul_f32 v243, v243, v234
  v_fmac_f32 v211, v210, v203
  v_fma_f32 v210, v210, v202, -v222
  v_fmac_f32 v243, v242, v235
  v_fma_f32 v242, v242, v234, -v254
  v_cvt_pk_bf16_f32 v48, v210, v211
  v_cvt_pk_bf16_f32 v49, v242, v243
  ds_write_b64 v57, v[48:49] offset:6864
  v_mul_f32 v222, v211, v203
  v_mul_f32 v211, v211, v202
  v_mul_f32 v254, v243, v235
  v_mul_f32 v243, v243, v234
  v_fmac_f32 v211, v210, v203
  v_fma_f32 v210, v210, v202, -v222
  v_fmac_f32 v243, v242, v235
  v_fma_f32 v242, v242, v234, -v254
  v_cvt_pk_bf16_f32 v50, v210, v211
  v_cvt_pk_bf16_f32 v51, v242, v243
  ds_write_b64 v57, v[50:51] offset:7392
  v_mul_f32 v222, v211, v203
  v_mul_f32 v211, v211, v202
  v_mul_f32 v254, v243, v235
  v_mul_f32 v243, v243, v234
  v_fmac_f32 v211, v210, v203
  v_fma_f32 v210, v210, v202, -v222
  v_fmac_f32 v243, v242, v235
  v_fma_f32 v242, v242, v234, -v254
  v_cvt_pk_bf16_f32 v52, v210, v211
  v_cvt_pk_bf16_f32 v53, v242, v243
  ds_write_b64 v57, v[52:53] offset:7920
  v_mul_f32 v222, v211, v203
  v_mul_f32 v211, v211, v202
  v_mul_f32 v254, v243, v235
  v_mul_f32 v243, v243, v234
  v_fmac_f32 v211, v210, v203
  v_fma_f32 v210, v210, v202, -v222
  v_fmac_f32 v243, v242, v235
  v_fma_f32 v242, v242, v234, -v254
  v_cvt_pk_bf16_f32 v54, v210, v211
  v_cvt_pk_bf16_f32 v55, v242, v243
  ds_write_b64 v57, v[54:55] offset:8448
  v_mul_f32 v222, v211, v203
  v_mul_f32 v211, v211, v202
  v_mul_f32 v254, v243, v235
  v_mul_f32 v243, v243, v234
  v_fmac_f32 v211, v210, v203
  v_fma_f32 v210, v210, v202, -v222
  v_fmac_f32 v243, v242, v235
  v_fma_f32 v242, v242, v234, -v254
  v_cvt_pk_bf16_f32 v40, v210, v211
  v_cvt_pk_bf16_f32 v41, v242, v243
  ds_write_b64 v57, v[40:41] offset:8976
  v_mul_f32 v222, v211, v203
  v_mul_f32 v211, v211, v202
  v_mul_f32 v254, v243, v235
  v_mul_f32 v243, v243, v234
  v_fmac_f32 v211, v210, v203
  v_fma_f32 v210, v210, v202, -v222
  v_fmac_f32 v243, v242, v235
  v_fma_f32 v242, v242, v234, -v254
  v_cvt_pk_bf16_f32 v42, v210, v211
  v_cvt_pk_bf16_f32 v43, v242, v243
  ds_write_b64 v57, v[42:43] offset:9504
  v_mul_f32 v222, v211, v203
  v_mul_f32 v211, v211, v202
  v_mul_f32 v254, v243, v235
  v_mul_f32 v243, v243, v234
  v_fmac_f32 v211, v210, v203
  v_fma_f32 v210, v210, v202, -v222
  v_fmac_f32 v243, v242, v235
  v_fma_f32 v242, v242, v234, -v254
  v_cvt_pk_bf16_f32 v44, v210, v211
  v_cvt_pk_bf16_f32 v45, v242, v243
  ds_write_b64 v57, v[44:45] offset:10032
  v_mul_f32 v222, v211, v203
  v_mul_f32 v211, v211, v202
  v_mul_f32 v254, v243, v235
  v_mul_f32 v243, v243, v234
  v_fmac_f32 v211, v210, v203
  v_fma_f32 v210, v210, v202, -v222
  v_fmac_f32 v243, v242, v235
  v_fma_f32 v242, v242, v234, -v254
  v_cvt_pk_bf16_f32 v46, v210, v211
  v_cvt_pk_bf16_f32 v47, v242, v243
  ds_write_b64 v57, v[46:47] offset:10560
  v_mul_f32 v222, v211, v203
  v_mul_f32 v211, v211, v202
  v_mul_f32 v254, v243, v235
  v_mul_f32 v243, v243, v234
  v_fmac_f32 v211, v210, v203
  v_fma_f32 v210, v210, v202, -v222
  v_fmac_f32 v243, v242, v235
  v_fma_f32 v242, v242, v234, -v254
  v_cvt_pk_bf16_f32 v48, v210, v211
  v_cvt_pk_bf16_f32 v49, v242, v243
  ds_write_b64 v57, v[48:49] offset:11088
  v_mul_f32 v222, v211, v203
  v_mul_f32 v211, v211, v202
  v_mul_f32 v254, v243, v235
  v_mul_f32 v243, v243, v234
  v_fmac_f32 v211, v210, v203
  v_fma_f32 v210, v210, v202, -v222
  v_fmac_f32 v243, v242, v235
  v_fma_f32 v242, v242, v234, -v254
  v_cvt_pk_bf16_f32 v50, v210, v211
  v_cvt_pk_bf16_f32 v51, v242, v243
  ds_write_b64 v57, v[50:51] offset:11616
  v_mul_f32 v222, v211, v203
  v_mul_f32 v211, v211, v202
  v_mul_f32 v254, v243, v235
  v_mul_f32 v243, v243, v234
  v_fmac_f32 v211, v210, v203
  v_fma_f32 v210, v210, v202, -v222
  v_fmac_f32 v243, v242, v235
  v_fma_f32 v242, v242, v234, -v254
  v_cvt_pk_bf16_f32 v52, v210, v211
  v_cvt_pk_bf16_f32 v53, v242, v243
  ds_write_b64 v57, v[52:53] offset:12144
  v_mul_f32 v222, v211, v203
  v_mul_f32 v211, v211, v202
  v_mul_f32 v254, v243, v235
  v_mul_f32 v243, v243, v234
  v_fmac_f32 v211, v210, v203
  v_fma_f32 v210, v210, v202, -v222
  v_fmac_f32 v243, v242, v235
  v_fma_f32 v242, v242, v234, -v254
  v_cvt_pk_bf16_f32 v54, v210, v211
  v_cvt_pk_bf16_f32 v55, v242, v243
  ds_write_b64 v57, v[54:55] offset:12672
  v_mul_f32 v222, v211, v203
  v_mul_f32 v211, v211, v202
  v_mul_f32 v254, v243, v235
  v_mul_f32 v243, v243, v234
  v_fmac_f32 v211, v210, v203
  v_fma_f32 v210, v210, v202, -v222
  v_fmac_f32 v243, v242, v235
  v_fma_f32 v242, v242, v234, -v254
  v_cvt_pk_bf16_f32 v40, v210, v211
  v_cvt_pk_bf16_f32 v41, v242, v243
  ds_write_b64 v57, v[40:41] offset:13200
  v_mul_f32 v222, v211, v203
  v_mul_f32 v211, v211, v202
  v_mul_f32 v254, v243, v235
  v_mul_f32 v243, v243, v234
  v_fmac_f32 v211, v210, v203
  v_fma_f32 v210, v210, v202, -v222
  v_fmac_f32 v243, v242, v235
  v_fma_f32 v242, v242, v234, -v254
  v_cvt_pk_bf16_f32 v42, v210, v211
  v_cvt_pk_bf16_f32 v43, v242, v243
  ds_write_b64 v57, v[42:43] offset:13728
  v_mul_f32 v222, v211, v203
  v_mul_f32 v211, v211, v202
  v_mul_f32 v254, v243, v235
  v_mul_f32 v243, v243, v234
  v_fmac_f32 v211, v210, v203
  v_fma_f32 v210, v210, v202, -v222
  v_fmac_f32 v243, v242, v235
  v_fma_f32 v242, v242, v234, -v254
  v_cvt_pk_bf16_f32 v44, v210, v211
  v_cvt_pk_bf16_f32 v45, v242, v243
  ds_write_b64 v57, v[44:45] offset:14256
  v_mul_f32 v222, v211, v203
  v_mul_f32 v211, v211, v202
  v_mul_f32 v254, v243, v235
  v_mul_f32 v243, v243, v234
  v_fmac_f32 v211, v210, v203
  v_fma_f32 v210, v210, v202, -v222
  v_fmac_f32 v243, v242, v235
  v_fma_f32 v242, v242, v234, -v254
  v_cvt_pk_bf16_f32 v46, v210, v211
  v_cvt_pk_bf16_f32 v47, v242, v243
  ds_write_b64 v57, v[46:47] offset:14784
  v_mul_f32 v222, v211, v203
  v_mul_f32 v211, v211, v202
  v_mul_f32 v254, v243, v235
  v_mul_f32 v243, v243, v234
  v_fmac_f32 v211, v210, v203
  v_fma_f32 v210, v210, v202, -v222
  v_fmac_f32 v243, v242, v235
  v_fma_f32 v242, v242, v234, -v254
  v_cvt_pk_bf16_f32 v48, v210, v211
  v_cvt_pk_bf16_f32 v49, v242, v243
  ds_write_b64 v57, v[48:49] offset:15312
  v_mul_f32 v222, v211, v203
  v_mul_f32 v211, v211, v202
  v_mul_f32 v254, v243, v235
  v_mul_f32 v243, v243, v234
  v_fmac_f32 v211, v210, v203
  v_fma_f32 v210, v210, v202, -v222
  v_fmac_f32 v243, v242, v235
  v_fma_f32 v242, v242, v234, -v254
  v_cvt_pk_bf16_f32 v50, v210, v211
  v_cvt_pk_bf16_f32 v51, v242, v243
  ds_write_b64 v57, v[50:51] offset:15840
  v_mul_f32 v222, v211, v203
  v_mul_f32 v211, v211, v202
  v_mul_f32 v254, v243, v235
  v_mul_f32 v243, v243, v234
  v_fmac_f32 v211, v210, v203
  v_fma_f32 v210, v210, v202, -v222
  v_fmac_f32 v243, v242, v235
  v_fma_f32 v242, v242, v234, -v254
  v_cvt_pk_bf16_f32 v52, v210, v211
  v_cvt_pk_bf16_f32 v53, v242, v243
  ds_write_b64 v57, v[52:53] offset:16368
  s_waitcnt lgkmcnt(0)
  ds_read_b128 v[64:67], v58 offset:0
  ds_read_b128 v[68:71], v58 offset:32
  ds_read_b128 v[72:75], v58 offset:64
  ds_read_b128 v[76:79], v58 offset:96
  ds_read_b128 v[80:83], v58 offset:128
  ds_read_b128 v[84:87], v58 offset:160
  ds_read_b128 v[88:91], v58 offset:192
  ds_read_b128 v[92:95], v58 offset:224
  ds_read_b128 v[96:99], v58 offset:256
  ds_read_b128 v[100:103], v58 offset:288
  ds_read_b128 v[104:107], v58 offset:320
  ds_read_b128 v[108:111], v58 offset:352
  ds_read_b128 v[112:115], v58 offset:384
  ds_read_b128 v[116:119], v58 offset:416
  ds_read_b128 v[120:123], v58 offset:448
  ds_read_b128 v[124:127], v58 offset:480
  s_waitcnt lgkmcnt(0)
  v_cvt_pk_bf16_f32 v54, v198, v199
  v_cvt_pk_bf16_f32 v55, v230, v231
  ds_write_b64 v57, v[54:55] offset:0
  v_mul_f32 v222, v199, v201
  v_mul_f32 v211, v199, v200
  v_mul_f32 v254, v231, v233
  v_mul_f32 v243, v231, v232
  v_fmac_f32 v211, v198, v201
  v_fma_f32 v210, v198, v200, -v222
  v_fmac_f32 v243, v230, v233
  v_fma_f32 v242, v230, v232, -v254
  v_cvt_pk_bf16_f32 v40, v210, v211
  v_cvt_pk_bf16_f32 v41, v242, v243
  ds_write_b64 v57, v[40:41] offset:528
  v_mul_f32 v222, v211, v201
  v_mul_f32 v213, v211, v200
  v_mul_f32 v254, v243, v233
  v_mul_f32 v245, v243, v232
  v_fmac_f32 v213, v210, v201
  v_fma_f32 v212, v210, v200, -v222
  v_fmac_f32 v245, v242, v233
  v_fma_f32 v244, v242, v232, -v254
  v_cvt_pk_bf16_f32 v42, v212, v213
  v_cvt_pk_bf16_f32 v43, v244, v245
  ds_write_b64 v57, v[42:43] offset:1056
  v_mul_f32 v222, v213, v201
  v_mul_f32 v211, v213, v200
  v_mul_f32 v254, v245, v233
  v_mul_f32 v243, v245, v232
  v_fmac_f32 v211, v212, v201
  v_fma_f32 v210, v212, v200, -v222
  v_fmac_f32 v243, v244, v233
  v_fma_f32 v242, v244, v232, -v254
  v_cvt_pk_bf16_f32 v44, v210, v211
  v_cvt_pk_bf16_f32 v45, v242, v243
  ds_write_b64 v57, v[44:45] offset:1584
  v_mul_f32 v222, v211, v201
  v_mul_f32 v215, v211, v200
  v_mul_f32 v254, v243, v233
  v_mul_f32 v247, v243, v232
  v_fmac_f32 v215, v210, v201
  v_fma_f32 v214, v210, v200, -v222
  v_fmac_f32 v247, v242, v233
  v_fma_f32 v246, v242, v232, -v254
  v_cvt_pk_bf16_f32 v46, v214, v215
  v_cvt_pk_bf16_f32 v47, v246, v247
  ds_write_b64 v57, v[46:47] offset:2112
  v_mul_f32 v222, v215, v201
  v_mul_f32 v211, v215, v200
  v_mul_f32 v254, v247, v233
  v_mul_f32 v243, v247, v232
  v_fmac_f32 v211, v214, v201
  v_fma_f32 v210, v214, v200, -v222
  v_fmac_f32 v243, v246, v233
  v_fma_f32 v242, v246, v232, -v254
  v_cvt_pk_bf16_f32 v48, v210, v211
  v_cvt_pk_bf16_f32 v49, v242, v243
  ds_write_b64 v57, v[48:49] offset:2640
  v_mul_f32 v222, v211, v201
  v_mul_f32 v217, v211, v200
  v_mul_f32 v254, v243, v233
  v_mul_f32 v249, v243, v232
  v_fmac_f32 v217, v210, v201
  v_fma_f32 v216, v210, v200, -v222
  v_fmac_f32 v249, v242, v233
  v_fma_f32 v248, v242, v232, -v254
  v_cvt_pk_bf16_f32 v50, v216, v217
  v_cvt_pk_bf16_f32 v51, v248, v249
  ds_write_b64 v57, v[50:51] offset:3168
  v_mul_f32 v222, v217, v201
  v_mul_f32 v211, v217, v200
  v_mul_f32 v254, v249, v233
  v_mul_f32 v243, v249, v232
  v_fmac_f32 v211, v216, v201
  v_fma_f32 v210, v216, v200, -v222
  v_fmac_f32 v243, v248, v233
  v_fma_f32 v242, v248, v232, -v254
  v_cvt_pk_bf16_f32 v52, v210, v211
  v_cvt_pk_bf16_f32 v53, v242, v243
  ds_write_b64 v57, v[52:53] offset:3696
  v_mul_f32 v222, v199, v205
  v_mul_f32 v211, v199, v204
  v_mul_f32 v254, v231, v237
  v_mul_f32 v243, v231, v236
  v_fmac_f32 v211, v198, v205
  v_fma_f32 v210, v198, v204, -v222
  v_fmac_f32 v243, v230, v237
  v_fma_f32 v242, v230, v236, -v254
  v_cvt_pk_bf16_f32 v54, v210, v211
  v_cvt_pk_bf16_f32 v55, v242, v243
  ds_write_b64 v57, v[54:55] offset:4224
  v_mul_f32 v222, v213, v205
  v_mul_f32 v211, v213, v204
  v_mul_f32 v254, v245, v237
  v_mul_f32 v243, v245, v236
  v_fmac_f32 v211, v212, v205
  v_fma_f32 v210, v212, v204, -v222
  v_fmac_f32 v243, v244, v237
  v_fma_f32 v242, v244, v236, -v254
  v_cvt_pk_bf16_f32 v40, v210, v211
  v_cvt_pk_bf16_f32 v41, v242, v243
  ds_write_b64 v57, v[40:41] offset:4752
  v_mul_f32 v222, v215, v205
  v_mul_f32 v211, v215, v204
  v_mul_f32 v254, v247, v237
  v_mul_f32 v243, v247, v236
  v_fmac_f32 v211, v214, v205
  v_fma_f32 v210, v214, v204, -v222
  v_fmac_f32 v243, v246, v237
  v_fma_f32 v242, v246, v236, -v254
  v_cvt_pk_bf16_f32 v42, v210, v211
  v_cvt_pk_bf16_f32 v43, v242, v243
  ds_write_b64 v57, v[42:43] offset:5280
  v_mul_f32 v222, v217, v205
  v_mul_f32 v211, v217, v204
  v_mul_f32 v254, v249, v237
  v_mul_f32 v243, v249, v236
  v_fmac_f32 v211, v216, v205
  v_fma_f32 v210, v216, v204, -v222
  v_fmac_f32 v243, v248, v237
  v_fma_f32 v242, v248, v236, -v254
  v_cvt_pk_bf16_f32 v44, v210, v211
  v_cvt_pk_bf16_f32 v45, v242, v243
  ds_write_b64 v57, v[44:45] offset:5808
  v_mul_f32 v222, v199, v207
  v_mul_f32 v219, v199, v206
  v_mul_f32 v254, v231, v239
  v_mul_f32 v251, v231, v238
  v_fmac_f32 v219, v198, v207
  v_fma_f32 v218, v198, v206, -v222
  v_fmac_f32 v251, v230, v239
  v_fma_f32 v250, v230, v238, -v254
  v_cvt_pk_bf16_f32 v46, v218, v219
  v_cvt_pk_bf16_f32 v47, v250, v251
  ds_write_b64 v57, v[46:47] offset:6336
  v_mul_f32 v222, v215, v207
  v_mul_f32 v221, v215, v206
  v_mul_f32 v254, v247, v239
  v_mul_f32 v253, v247, v238
  v_fmac_f32 v221, v214, v207
  v_fma_f32 v220, v214, v206, -v222
  v_fmac_f32 v253, v246, v239
  v_fma_f32 v252, v246, v238, -v254
  v_cvt_pk_bf16_f32 v48, v220, v221
  v_cvt_pk_bf16_f32 v49, v252, v253
  ds_write_b64 v57, v[48:49] offset:6864
  v_mul_f32 v222, v219, v205
  v_mul_f32 v219, v219, v204
  v_mul_f32 v254, v251, v237
  v_mul_f32 v251, v251, v236
  v_fmac_f32 v219, v218, v205
  v_fma_f32 v218, v218, v204, -v222
  v_fmac_f32 v251, v250, v237
  v_fma_f32 v250, v250, v236, -v254
  v_cvt_pk_bf16_f32 v50, v218, v219
  v_cvt_pk_bf16_f32 v51, v250, v251
  ds_write_b64 v57, v[50:51] offset:7392
  v_mul_f32 v222, v221, v205
  v_mul_f32 v221, v221, v204
  v_mul_f32 v254, v253, v237
  v_mul_f32 v253, v253, v236
  v_fmac_f32 v221, v220, v205
  v_fma_f32 v220, v220, v204, -v222
  v_fmac_f32 v253, v252, v237
  v_fma_f32 v252, v252, v236, -v254
  v_cvt_pk_bf16_f32 v52, v220, v221
  v_cvt_pk_bf16_f32 v53, v252, v253
  ds_write_b64 v57, v[52:53] offset:7920
  v_mul_f32 v222, v199, v209
  v_mul_f32 v211, v199, v208
  v_mul_f32 v254, v231, v241
  v_mul_f32 v243, v231, v240
  v_fmac_f32 v211, v198, v209
  v_fma_f32 v210, v198, v208, -v222
  v_fmac_f32 v243, v230, v241
  v_fma_f32 v242, v230, v240, -v254
  v_cvt_pk_bf16_f32 v54, v210, v211
  v_cvt_pk_bf16_f32 v55, v242, v243
  ds_write_b64 v57, v[54:55] offset:8448
  v_mul_f32 v222, v211, v205
  v_mul_f32 v211, v211, v204
  v_mul_f32 v254, v243, v237
  v_mul_f32 v243, v243, v236
  v_fmac_f32 v211, v210, v205
  v_fma_f32 v210, v210, v204, -v222
  v_fmac_f32 v243, v242, v237
  v_fma_f32 v242, v242, v236, -v254
  v_cvt_pk_bf16_f32 v40, v210, v211
  v_cvt_pk_bf16_f32 v41, v242, v243
  ds_write_b64 v57, v[40:41] offset:8976
  v_mul_f32 v222, v211, v205
  v_mul_f32 v211, v211, v204
  v_mul_f32 v254, v243, v237
  v_mul_f32 v243, v243, v236
  v_fmac_f32 v211, v210, v205
  v_fma_f32 v210, v210, v204, -v222
  v_fmac_f32 v243, v242, v237
  v_fma_f32 v242, v242, v236, -v254
  v_cvt_pk_bf16_f32 v42, v210, v211
  v_cvt_pk_bf16_f32 v43, v242, v243
  ds_write_b64 v57, v[42:43] offset:9504
  v_mul_f32 v222, v211, v205
  v_mul_f32 v211, v211, v204
  v_mul_f32 v254, v243, v237
  v_mul_f32 v243, v243, v236
  v_fmac_f32 v211, v210, v205
  v_fma_f32 v210, v210, v204, -v222
  v_fmac_f32 v243, v242, v237
  v_fma_f32 v242, v242, v236, -v254
  v_cvt_pk_bf16_f32 v44, v210, v211
  v_cvt_pk_bf16_f32 v45, v242, v243
  ds_write_b64 v57, v[44:45] offset:10032
  v_mul_f32 v222, v211, v205
  v_mul_f32 v211, v211, v204
  v_mul_f32 v254, v243, v237
  v_mul_f32 v243, v243, v236
  v_fmac_f32 v211, v210, v205
  v_fma_f32 v210, v210, v204, -v222
  v_fmac_f32 v243, v242, v237
  v_fma_f32 v242, v242, v236, -v254
  v_cvt_pk_bf16_f32 v46, v210, v211
  v_cvt_pk_bf16_f32 v47, v242, v243
  ds_write_b64 v57, v[46:47] offset:10560
  s_cmp_lg_u32 s23, 0
  s_cbranch_scc1 Lafd_31
  s_lshl_b32 s26, s20, 12
  s_add_u32 s26, s26, 65536
  v_lshlrev_b32 v2, 7, v0
  s_mov_b32 s67, 0
  s_mov_b32 exec_hi, 0
Lafp_30:
  buffer_load_dword v3, v2, s[12:15], s26 offen sc1
  s_waitcnt vmcnt(0)
  v_cmp_ne_u32 vcc, s32, v3
  s_cbranch_vccz Lafd_31
  s_sleep 2
  s_add_u32 s67, s67, 1
  s_cmp_lt_u32 s67, 20000
  s_cbranch_scc1 Lafp_30
Lafd_31:
  s_mov_b64 exec, -1
  s_waitcnt lgkmcnt(0)
  s_barrier
  v_lshrrev_b32 v2, 3, v0
  v_mul_u32_u24 v2, 8448, v2
  v_and_b32 v3, 7, v0
  v_lshlrev_b32 v3, 4, v3
  v_add_u32 v60, v2, v3
  s_lshl_b32 s26, s20, 5
  s_lshl_b32 s27, s25, 4
  s_add_u32 s26, s26, s27
  s_mul_i32 s26, s26, 8448
  s_lshl_b32 s27, s22, 1
  s_add_u32 s27, s27, s24
  s_and_b32 s27, s27, 63
  s_lshl_b32 s27, s27, 7
  s_add_u32 s62, s26, s27
  s_mul_i32 s35, s24, 4576
  s_lshl_b32 s27, s25, 11
  s_add_u32 s35, s35, s27
  s_add_u32 s35, s35, 68000
  s_add_u32 m0, s35, 0
  s_add_u32 s26, s62, 6291456
  buffer_load_dwordx4 v60, s[12:15], s26 offen sc1 lds
  s_add_u32 m0, s35, 1024
  s_add_u32 s26, s62, 6359040
  buffer_load_dwordx4 v60, s[12:15], s26 offen sc1 lds
  v_mov_b32 v10, 0
  v_mov_b32 v11, 0
  v_mov_b32 v12, 0
  v_mov_b32 v13, 0
  s_mul_i32 s26, s24, 4576
  s_add_u32 s26, s26, 67520
  v_add_u32 v2, s26, v9
  s_mov_b32 exec_lo, 0x3fffffff
  s_mov_b32 exec_hi, 0
  ds_write_b128 v2, v[10:13]
  s_mov_b64 exec, -1
  s_waitcnt lgkmcnt(0)
  ds_read_b128 v[128:131], v58 offset:0
  ds_read_b128 v[132:135], v58 offset:32
  ds_read_b128 v[136:139], v58 offset:64
  ds_read_b128 v[140:143], v58 offset:96
  ds_read_b128 v[144:147], v58 offset:128
  ds_read_b128 v[148:151], v58 offset:160
  ds_read_b128 v[152:155], v58 offset:192
  ds_read_b128 v[156:159], v58 offset:224
  s_waitcnt lgkmcnt(7)
  v_mfma_f32_32x32x16_bf16 v[16:31], v[128:131], v[64:67], 0
  s_waitcnt lgkmcnt(6)
  v_mfma_f32_32x32x16_bf16 v[16:31], v[132:135], v[68:71], v[16:31]
  s_waitcnt lgkmcnt(5)
  v_mfma_f32_32x32x16_bf16 v[16:31], v[136:139], v[72:75], v[16:31]
  s_waitcnt lgkmcnt(4)
  v_mfma_f32_32x32x16_bf16 v[16:31], v[140:143], v[76:79], v[16:31]
  ds_read_b128 v[128:131], v58 offset:256
  ds_read_b128 v[132:135], v58 offset:288
  ds_read_b128 v[136:139], v58 offset:320
  ds_read_b128 v[140:143], v58 offset:352
  s_waitcnt lgkmcnt(7)
  v_mfma_f32_32x32x16_bf16 v[16:31], v[144:147], v[80:83], v[16:31]
  s_waitcnt lgkmcnt(6)
  v_mfma_f32_32x32x16_bf16 v[16:31], v[148:151], v[84:87], v[16:31]
  s_waitcnt lgkmcnt(5)
  v_mfma_f32_32x32x16_bf16 v[16:31], v[152:155], v[88:91], v[16:31]
  s_waitcnt lgkmcnt(4)
  v_mfma_f32_32x32x16_bf16 v[16:31], v[156:159], v[92:95], v[16:31]
  ds_read_b128 v[144:147], v58 offset:384
  ds_read_b128 v[148:151], v58 offset:416
  ds_read_b128 v[152:155], v58 offset:448
  ds_read_b128 v[156:159], v58 offset:480
  s_waitcnt lgkmcnt(7)
  v_mfma_f32_32x32x16_bf16 v[16:31], v[128:131], v[96:99], v[16:31]
  s_waitcnt lgkmcnt(6)
  v_mfma_f32_32x32x16_bf16 v[16:31], v[132:135], v[100:103], v[16:31]
  s_waitcnt lgkmcnt(5)
  v_mfma_f32_32x32x16_bf16 v[16:31], v[136:139], v[104:107], v[16:31]
  s_waitcnt lgkmcnt(4)
  v_mfma_f32_32x32x16_bf16 v[16:31], v[140:143], v[108:111], v[16:31]
  s_waitcnt lgkmcnt(3)
  v_mfma_f32_32x32x16_bf16 v[16:31], v[144:147], v[112:115], v[16:31]
  s_waitcnt lgkmcnt(2)
  v_mfma_f32_32x32x16_bf16 v[16:31], v[148:151], v[116:119], v[16:31]
  s_waitcnt lgkmcnt(1)
  v_mfma_f32_32x32x16_bf16 v[16:31], v[152:155], v[120:123], v[16:31]
  s_waitcnt lgkmcnt(0)
  v_mfma_f32_32x32x16_bf16 v[16:31], v[156:159], v[124:127], v[16:31]
  v_mov_b32 v1, 76672
  v_add_u32_sdwa v160, v1, v172 dst_sel:DWORD dst_unused:UNUSED_PAD src0_sel:DWORD src1_sel:WORD_0
  v_add_u32_sdwa v161, v1, v172 dst_sel:DWORD dst_unused:UNUSED_PAD src0_sel:DWORD src1_sel:WORD_1
  v_add_u32_sdwa v162, v1, v173 dst_sel:DWORD dst_unused:UNUSED_PAD src0_sel:DWORD src1_sel:WORD_0
  v_add_u32_sdwa v163, v1, v173 dst_sel:DWORD dst_unused:UNUSED_PAD src0_sel:DWORD src1_sel:WORD_1
  v_add_u32_sdwa v164, v1, v174 dst_sel:DWORD dst_unused:UNUSED_PAD src0_sel:DWORD src1_sel:WORD_0
  v_add_u32_sdwa v165, v1, v174 dst_sel:DWORD dst_unused:UNUSED_PAD src0_sel:DWORD src1_sel:WORD_1
  v_add_u32_sdwa v166, v1, v175 dst_sel:DWORD dst_unused:UNUSED_PAD src0_sel:DWORD src1_sel:WORD_0
  v_add_u32_sdwa v167, v1, v175 dst_sel:DWORD dst_unused:UNUSED_PAD src0_sel:DWORD src1_sel:WORD_1
  v_add_u32_sdwa v168, v1, v176 dst_sel:DWORD dst_unused:UNUSED_PAD src0_sel:DWORD src1_sel:WORD_0
  v_add_u32_sdwa v169, v1, v176 dst_sel:DWORD dst_unused:UNUSED_PAD src0_sel:DWORD src1_sel:WORD_1
  v_add_u32_sdwa v170, v1, v177 dst_sel:DWORD dst_unused:UNUSED_PAD src0_sel:DWORD src1_sel:WORD_0
  s_mul_i32 s26, s24, 2624
  s_add_u32 s26, s26, 76672
  v_and_b32 v3, 31, v0
  v_lshrrev_b32 v4, 5, v0
  v_cmp_eq_u32 vcc, 1, v4
  v_lshlrev_b32 v10, 5, v3
  v_lshlrev_b32 v6, 4, v4
  v_add_u32 v10, v10, v6
  v_add_u32 v10, s26, v10
  v_lshlrev_b32 v6, 4, v3
  v_add_u32 v6, 1024, v6
  v_lshlrev_b32 v7, 3, v3
  v_add_u32 v7, 1536, v7
  v_cndmask_b32 v6, v6, v7, vcc
  v_add_u32 v7, 8, v6
  v_add_u32 v8, 256, v6
  v_cndmask_b32 v7, v7, v8, vcc
  v_add_u32 v6, s26, v6
  v_add_u32 v7, s26, v7
  v_lshlrev_b32 v8, 2, v3
  v_add_u32 v8, 2048, v8
  v_mov_b32 v14, 2560
  v_cndmask_b32 v8, v8, v14, vcc
  v_add_u32 v8, s26, v8
  v_lshrrev_b32 v3, 3, v0
  s_lshl_b32 s26, s23, 4
  v_add_u32 v3, s26, v3
  v_and_b32 v4, 7, v0
  v_lshlrev_b32 v4, 4, v4
  v_mul_u32_u24 v5, 896, v3
  v_add_u32 v5, v5, v4
  v_lshlrev_b32 v61, 7, v3
  v_add_u32 v61, v61, v4
  s_nop 1
  s_mul_i32 s26, s23, 16880
  v_add_u32 v2, s26, v9
  s_xor_b32 s26, s23, 1
  s_mul_i32 s26, s26, 16880
  v_add_u32 v12, s26, v9
  s_cmp_lg_u32 s25, 0
  s_cbranch_scc1 Lkh1_32
  ds_write_b128 v2, v[24:27]
  s_waitcnt lgkmcnt(0)
  s_barrier
  ds_read_b128 v[64:67], v12
  ds_read_b128 v[68:71], v12 offset:1024
  s_waitcnt lgkmcnt(0)
  v_add_f32 v16, v16, v64
  v_add_f32 v17, v17, v65
  v_add_f32 v18, v18, v66
  v_add_f32 v19, v19, v67
  v_add_f32 v20, v20, v68
  v_add_f32 v21, v21, v69
  v_add_f32 v22, v22, v70
  v_add_f32 v23, v23, v71
  ds_write_b128 v10, v[16:19]
  ds_write_b64 v6, v[20:21]
  ds_write_b64 v7, v[22:23]
  s_branch Lkh2_33
Lkh1_32:
  ds_write_b128 v2, v[16:19]
  ds_write_b128 v2, v[20:23] offset:1024
  s_waitcnt lgkmcnt(0)
  s_barrier
  ds_read_b128 v[64:67], v12
  s_waitcnt lgkmcnt(0)
  v_add_f32 v24, v24, v64
  v_add_f32 v25, v25, v65
  v_add_f32 v26, v26, v66
  v_add_f32 v27, v27, v67
  s_mov_b32 exec_hi, 1
  ds_write_b32 v8, v24
  s_mov_b32 exec_hi, 0
  ds_write_b32 v8, v25 offset:128
  ds_write_b32 v8, v26 offset:256
  ds_write_b32 v8, v27 offset:384
  s_mov_b32 exec_hi, -1
Lkh2_33:
  s_lshl_b32 s26, s23, 6
  v_add_u32 v2, s26, v0
  v_lshlrev_b32 v4, 4, v2
  s_waitcnt lgkmcnt(0)
  s_barrier
  ds_read_b32 v64, v160 offset:0
  ds_read_b32 v65, v161 offset:0
  ds_read_b32 v66, v162 offset:0
  ds_read_b32 v67, v163 offset:0
  ds_read_b32 v68, v164 offset:0
  ds_read_b32 v69, v165 offset:0
  ds_read_b32 v70, v166 offset:0
  ds_read_b32 v71, v167 offset:0
  ds_read_b32 v72, v168 offset:0
  ds_read_b32 v73, v169 offset:0
  ds_read_b32 v74, v170 offset:0
  ds_read_b32 v80, v160 offset:2624
  ds_read_b32 v81, v161 offset:2624
  ds_read_b32 v82, v162 offset:2624
  ds_read_b32 v83, v163 offset:2624
  ds_read_b32 v84, v164 offset:2624
  ds_read_b32 v85, v165 offset:2624
  ds_read_b32 v86, v166 offset:2624
  ds_read_b32 v87, v167 offset:2624
  ds_read_b32 v88, v168 offset:2624
  ds_read_b32 v89, v169 offset:2624
  ds_read_b32 v90, v170 offset:2624
  v_lshrrev_b32 v6, 4, v0
  v_lshlrev_b32 v6, 4, v6
  s_lshl_b32 s26, s20, 7
  v_add_u32 v6, s26, v6
  global_load_dwordx4 v[224:227], v6, s[56:57]
  global_load_dwordx4 v[228:231], v6, s[56:57] offset:64
  v_lshrrev_b32 v7, 1, v0
  v_and_b32 v8, 3, v7
  v_mul_u32_u24 v8, 4160, v8
  v_lshrrev_b32 v7, 2, v7
  v_mul_u32_u24 v7, 16640, v7
  v_add_u32 v8, v8, v7
  v_and_b32 v7, 1, v0
  v_lshlrev_b32 v7, 4, v7
  v_add_u32 v8, v8, v7
  v_mov_b32 v10, 0
  v_mov_b32 v11, 0
  v_mov_b32 v12, 0
  v_mov_b32 v13, 0
  s_mov_b64 exec, 0xffff
  ds_write_b128 v8, v[10:13] offset:20480
  s_mov_b64 exec, -1
  s_waitcnt lgkmcnt(12)
  v_cvt_pk_bf16_f32 v96, v64, v65
  v_cvt_pk_bf16_f32 v97, v66, v67
  v_cvt_pk_bf16_f32 v98, v68, v69
  v_cvt_pk_bf16_f32 v99, v70, v71
  v_cvt_pk_bf16_f32 v100, v65, v66
  v_cvt_pk_bf16_f32 v101, v67, v68
  v_cvt_pk_bf16_f32 v102, v69, v70
  v_cvt_pk_bf16_f32 v103, v71, v72
  v_cvt_pk_bf16_f32 v104, v66, v67
  v_cvt_pk_bf16_f32 v105, v68, v69
  v_cvt_pk_bf16_f32 v106, v70, v71
  v_cvt_pk_bf16_f32 v107, v72, v73
  v_cvt_pk_bf16_f32 v108, v67, v68
  v_cvt_pk_bf16_f32 v109, v69, v70
  v_cvt_pk_bf16_f32 v110, v71, v72
  v_cvt_pk_bf16_f32 v111, v73, v74
  ds_write_b128 v4, v[96:99] offset:16384
  ds_write_b128 v4, v[100:103] offset:20544
  ds_write_b128 v4, v[104:107] offset:24704
  ds_write_b128 v4, v[108:111] offset:28864
  s_waitcnt lgkmcnt(4)
  v_cvt_pk_bf16_f32 v96, v80, v81
  v_cvt_pk_bf16_f32 v97, v82, v83
  v_cvt_pk_bf16_f32 v98, v84, v85
  v_cvt_pk_bf16_f32 v99, v86, v87
  v_cvt_pk_bf16_f32 v100, v81, v82
  v_cvt_pk_bf16_f32 v101, v83, v84
  v_cvt_pk_bf16_f32 v102, v85, v86
  v_cvt_pk_bf16_f32 v103, v87, v88
  v_cvt_pk_bf16_f32 v104, v82, v83
  v_cvt_pk_bf16_f32 v105, v84, v85
  v_cvt_pk_bf16_f32 v106, v86, v87
  v_cvt_pk_bf16_f32 v107, v88, v89
  v_cvt_pk_bf16_f32 v108, v83, v84
  v_cvt_pk_bf16_f32 v109, v85, v86
  v_cvt_pk_bf16_f32 v110, v87, v88
  v_cvt_pk_bf16_f32 v111, v89, v90
  ds_write_b128 v4, v[96:99] offset:33024
  ds_write_b128 v4, v[100:103] offset:37184
  ds_write_b128 v4, v[104:107] offset:41344
  ds_write_b128 v4, v[108:111] offset:45504
  v_and_b32 v2, 15, v0
  v_lshrrev_b32 v3, 4, v0
  v_and_b32 v5, 1, v3
  v_lshrrev_b32 v6, 1, v3
  v_sub_u32 v7, 3, v2
  v_and_b32 v7, 3, v7
  v_lshlrev_b32 v8, 4, v6
  v_add_u32 v8, v8, v2
  v_lshlrev_b32 v14, 3, v5
  v_sub_u32 v8, v8, v14
  v_add_u32 v8, v8, v7
  v_sub_u32 v8, 2047, v8
  v_lshlrev_b32 v8, 1, v8
  v_mul_u32_u24 v14, 4160, v7
  v_add_u32 v8, v8, v14
  s_mul_i32 s26, s24, 16640
  s_lshl_b32 s27, s25, 8
  s_sub_u32 s26, s26, s27
  s_add_u32 s26, s26, 12608
  v_add_u32 v48, s26, v8
  v_lshlrev_b32 v7, 4, v5
  v_lshlrev_b32 v8, 5, v6
  v_sub_u32 v7, v7, v8
  v_lshlrev_b32 v14, 5, v2
  v_add_u32 v14, v14, v7
  s_mul_i32 s26, s24, 4576
  s_sub_u32 s26, s26, s27
  s_add_u32 s26, s26, 67808
  v_add_u32 v56, s26, v14
  s_waitcnt vmcnt(2) lgkmcnt(0)
  s_barrier
  ds_read_b128 v[96:99], v56 offset:192
  ds_read_b128 v[100:103], v56 offset:704
  ds_read_b128 v[104:107], v56 offset:1216
  ds_read_b128 v[108:111], v56 offset:1728
  ds_read_b128 v[112:115], v56 offset:2240
  ds_read_b128 v[116:119], v56 offset:2752
  ds_read_b128 v[120:123], v56 offset:3264
  ds_read_b128 v[124:127], v56 offset:3776
  ds_read_b64 v[64:65], v48 offset:3776
  ds_read_b64 v[66:67], v48 offset:3784
  ds_read_b64 v[68:69], v48 offset:3264
  ds_read_b64 v[70:71], v48 offset:3272
  ds_read_b64 v[72:73], v48 offset:2752
  ds_read_b64 v[74:75], v48 offset:2760
  ds_read_b64 v[76:77], v48 offset:2240
  ds_read_b64 v[78:79], v48 offset:2248
  ds_read_b64 v[80:81], v48 offset:1728
  ds_read_b64 v[82:83], v48 offset:1736
  ds_read_b64 v[84:85], v48 offset:1216
  ds_read_b64 v[86:87], v48 offset:1224
  ds_read_b64 v[88:89], v48 offset:704
  ds_read_b64 v[90:91], v48 offset:712
  ds_read_b64 v[92:93], v48 offset:192
  ds_read_b64 v[94:95], v48 offset:200
  s_waitcnt lgkmcnt(0)
  v_mfma_f32_16x16x32_bf16 v[16:19], v[64:67], v[96:99], 0
  v_mfma_f32_16x16x32_bf16 v[20:23], v[64:67], v[100:103], 0
  ds_read_b128 v[192:195], v56 offset:128
  v_mfma_f32_16x16x32_bf16 v[24:27], v[64:67], v[104:107], 0
  ds_read_b128 v[196:199], v56 offset:640
  v_mfma_f32_16x16x32_bf16 v[28:31], v[64:67], v[108:111], 0
  ds_read_b128 v[200:203], v56 offset:1152
  v_mfma_f32_16x16x32_bf16 v[32:35], v[64:67], v[112:115], 0
  ds_read_b128 v[204:207], v56 offset:1664
  v_mfma_f32_16x16x32_bf16 v[36:39], v[64:67], v[116:119], 0
  ds_read_b128 v[208:211], v56 offset:2176
  v_mfma_f32_16x16x32_bf16 v[40:43], v[64:67], v[120:123], 0
  ds_read_b128 v[212:215], v56 offset:2688
  v_mfma_f32_16x16x32_bf16 v[44:47], v[64:67], v[124:127], 0
  ds_read_b128 v[216:219], v56 offset:3200
  v_mfma_f32_16x16x32_bf16 v[20:23], v[68:71], v[96:99], v[20:23]
  ds_read_b128 v[220:223], v56 offset:3712
  v_mfma_f32_16x16x32_bf16 v[24:27], v[68:71], v[100:103], v[24:27]
  ds_read_b64 v[128:129], v48 offset:3712
  v_mfma_f32_16x16x32_bf16 v[28:31], v[68:71], v[104:107], v[28:31]
  ds_read_b64 v[130:131], v48 offset:3720
  v_mfma_f32_16x16x32_bf16 v[32:35], v[68:71], v[108:111], v[32:35]
  ds_read_b64 v[132:133], v48 offset:3200
  v_mfma_f32_16x16x32_bf16 v[36:39], v[68:71], v[112:115], v[36:39]
  ds_read_b64 v[134:135], v48 offset:3208
  v_mfma_f32_16x16x32_bf16 v[40:43], v[68:71], v[116:119], v[40:43]
  ds_read_b64 v[136:137], v48 offset:2688
  v_mfma_f32_16x16x32_bf16 v[44:47], v[68:71], v[120:123], v[44:47]
  ds_read_b64 v[138:139], v48 offset:2696
  v_mfma_f32_16x16x32_bf16 v[24:27], v[72:75], v[96:99], v[24:27]
  ds_read_b64 v[140:141], v48 offset:2176
  v_mfma_f32_16x16x32_bf16 v[28:31], v[72:75], v[100:103], v[28:31]
  ds_read_b64 v[142:143], v48 offset:2184
  v_mfma_f32_16x16x32_bf16 v[32:35], v[72:75], v[104:107], v[32:35]
  ds_read_b64 v[144:145], v48 offset:1664
  v_mfma_f32_16x16x32_bf16 v[36:39], v[72:75], v[108:111], v[36:39]
  ds_read_b64 v[146:147], v48 offset:1672
  v_mfma_f32_16x16x32_bf16 v[40:43], v[72:75], v[112:115], v[40:43]
  ds_read_b64 v[148:149], v48 offset:1152
  v_mfma_f32_16x16x32_bf16 v[44:47], v[72:75], v[116:119], v[44:47]
  ds_read_b64 v[150:151], v48 offset:1160
  v_mfma_f32_16x16x32_bf16 v[28:31], v[76:79], v[96:99], v[28:31]
  ds_read_b64 v[152:153], v48 offset:640
  v_mfma_f32_16x16x32_bf16 v[32:35], v[76:79], v[100:103], v[32:35]
  ds_read_b64 v[154:155], v48 offset:648
  v_mfma_f32_16x16x32_bf16 v[36:39], v[76:79], v[104:107], v[36:39]
  ds_read_b64 v[156:157], v48 offset:128
  v_mfma_f32_16x16x32_bf16 v[40:43], v[76:79], v[108:111], v[40:43]
  ds_read_b64 v[158:159], v48 offset:136
  v_mfma_f32_16x16x32_bf16 v[44:47], v[76:79], v[112:115], v[44:47]
  v_mfma_f32_16x16x32_bf16 v[32:35], v[80:83], v[96:99], v[32:35]
  v_mfma_f32_16x16x32_bf16 v[36:39], v[80:83], v[100:103], v[36:39]
  v_mfma_f32_16x16x32_bf16 v[40:43], v[80:83], v[104:107], v[40:43]
  v_mfma_f32_16x16x32_bf16 v[44:47], v[80:83], v[108:111], v[44:47]
  v_mfma_f32_16x16x32_bf16 v[36:39], v[84:87], v[96:99], v[36:39]
  v_mfma_f32_16x16x32_bf16 v[40:43], v[84:87], v[100:103], v[40:43]
  v_mfma_f32_16x16x32_bf16 v[44:47], v[84:87], v[104:107], v[44:47]
  v_mfma_f32_16x16x32_bf16 v[40:43], v[88:91], v[96:99], v[40:43]
  v_mfma_f32_16x16x32_bf16 v[44:47], v[88:91], v[100:103], v[44:47]
  v_mfma_f32_16x16x32_bf16 v[44:47], v[92:95], v[96:99], v[44:47]
  s_waitcnt lgkmcnt(0)
  v_mfma_f32_16x16x32_bf16 v[16:19], v[128:131], v[192:195], v[16:19]
  v_mfma_f32_16x16x32_bf16 v[20:23], v[128:131], v[196:199], v[20:23]
  ds_read_b128 v[96:99], v56 offset:64
  v_mfma_f32_16x16x32_bf16 v[24:27], v[128:131], v[200:203], v[24:27]
  ds_read_b128 v[100:103], v56 offset:576
  v_mfma_f32_16x16x32_bf16 v[28:31], v[128:131], v[204:207], v[28:31]
  ds_read_b128 v[104:107], v56 offset:1088
  v_mfma_f32_16x16x32_bf16 v[32:35], v[128:131], v[208:211], v[32:35]
  ds_read_b128 v[108:111], v56 offset:1600
  v_mfma_f32_16x16x32_bf16 v[36:39], v[128:131], v[212:215], v[36:39]
  ds_read_b128 v[112:115], v56 offset:2112
  v_mfma_f32_16x16x32_bf16 v[40:43], v[128:131], v[216:219], v[40:43]
  ds_read_b128 v[116:119], v56 offset:2624
  v_mfma_f32_16x16x32_bf16 v[44:47], v[128:131], v[220:223], v[44:47]
  ds_read_b128 v[120:123], v56 offset:3136
  v_mfma_f32_16x16x32_bf16 v[20:23], v[132:135], v[192:195], v[20:23]
  ds_read_b128 v[124:127], v56 offset:3648
  v_mfma_f32_16x16x32_bf16 v[24:27], v[132:135], v[196:199], v[24:27]
  ds_read_b64 v[64:65], v48 offset:3648
  v_mfma_f32_16x16x32_bf16 v[28:31], v[132:135], v[200:203], v[28:31]
  ds_read_b64 v[66:67], v48 offset:3656
  v_mfma_f32_16x16x32_bf16 v[32:35], v[132:135], v[204:207], v[32:35]
  ds_read_b64 v[68:69], v48 offset:3136
  v_mfma_f32_16x16x32_bf16 v[36:39], v[132:135], v[208:211], v[36:39]
  ds_read_b64 v[70:71], v48 offset:3144
  v_mfma_f32_16x16x32_bf16 v[40:43], v[132:135], v[212:215], v[40:43]
  ds_read_b64 v[72:73], v48 offset:2624
  v_mfma_f32_16x16x32_bf16 v[44:47], v[132:135], v[216:219], v[44:47]
  ds_read_b64 v[74:75], v48 offset:2632
  v_mfma_f32_16x16x32_bf16 v[24:27], v[136:139], v[192:195], v[24:27]
  ds_read_b64 v[76:77], v48 offset:2112
  v_mfma_f32_16x16x32_bf16 v[28:31], v[136:139], v[196:199], v[28:31]
  ds_read_b64 v[78:79], v48 offset:2120
  v_mfma_f32_16x16x32_bf16 v[32:35], v[136:139], v[200:203], v[32:35]
  ds_read_b64 v[80:81], v48 offset:1600
  v_mfma_f32_16x16x32_bf16 v[36:39], v[136:139], v[204:207], v[36:39]
  ds_read_b64 v[82:83], v48 offset:1608
  v_mfma_f32_16x16x32_bf16 v[40:43], v[136:139], v[208:211], v[40:43]
  ds_read_b64 v[84:85], v48 offset:1088
  v_mfma_f32_16x16x32_bf16 v[44:47], v[136:139], v[212:215], v[44:47]
  ds_read_b64 v[86:87], v48 offset:1096
  v_mfma_f32_16x16x32_bf16 v[28:31], v[140:143], v[192:195], v[28:31]
  ds_read_b64 v[88:89], v48 offset:576
  v_mfma_f32_16x16x32_bf16 v[32:35], v[140:143], v[196:199], v[32:35]
  ds_read_b64 v[90:91], v48 offset:584
  v_mfma_f32_16x16x32_bf16 v[36:39], v[140:143], v[200:203], v[36:39]
  ds_read_b64 v[92:93], v48 offset:64
  v_mfma_f32_16x16x32_bf16 v[40:43], v[140:143], v[204:207], v[40:43]
  ds_read_b64 v[94:95], v48 offset:72
  v_mfma_f32_16x16x32_bf16 v[44:47], v[140:143], v[208:211], v[44:47]
  v_mfma_f32_16x16x32_bf16 v[32:35], v[144:147], v[192:195], v[32:35]
  v_mfma_f32_16x16x32_bf16 v[36:39], v[144:147], v[196:199], v[36:39]
  v_mfma_f32_16x16x32_bf16 v[40:43], v[144:147], v[200:203], v[40:43]
  v_mfma_f32_16x16x32_bf16 v[44:47], v[144:147], v[204:207], v[44:47]
  v_mfma_f32_16x16x32_bf16 v[36:39], v[148:151], v[192:195], v[36:39]
  v_mfma_f32_16x16x32_bf16 v[40:43], v[148:151], v[196:199], v[40:43]
  v_mfma_f32_16x16x32_bf16 v[44:47], v[148:151], v[200:203], v[44:47]
  v_mfma_f32_16x16x32_bf16 v[40:43], v[152:155], v[192:195], v[40:43]
  v_mfma_f32_16x16x32_bf16 v[44:47], v[152:155], v[196:199], v[44:47]
  v_mfma_f32_16x16x32_bf16 v[44:47], v[156:159], v[192:195], v[44:47]
  s_waitcnt lgkmcnt(0)
  v_mfma_f32_16x16x32_bf16 v[16:19], v[64:67], v[96:99], v[16:19]
  v_mfma_f32_16x16x32_bf16 v[20:23], v[64:67], v[100:103], v[20:23]
  ds_read_b128 v[192:195], v56 offset:0
  v_mfma_f32_16x16x32_bf16 v[24:27], v[64:67], v[104:107], v[24:27]
  ds_read_b128 v[196:199], v56 offset:512
  v_mfma_f32_16x16x32_bf16 v[28:31], v[64:67], v[108:111], v[28:31]
  ds_read_b128 v[200:203], v56 offset:1024
  v_mfma_f32_16x16x32_bf16 v[32:35], v[64:67], v[112:115], v[32:35]
  ds_read_b128 v[204:207], v56 offset:1536
  v_mfma_f32_16x16x32_bf16 v[36:39], v[64:67], v[116:119], v[36:39]
  ds_read_b128 v[208:211], v56 offset:2048
  v_mfma_f32_16x16x32_bf16 v[40:43], v[64:67], v[120:123], v[40:43]
  ds_read_b128 v[212:215], v56 offset:2560
  v_mfma_f32_16x16x32_bf16 v[44:47], v[64:67], v[124:127], v[44:47]
  ds_read_b128 v[216:219], v56 offset:3072
  v_mfma_f32_16x16x32_bf16 v[20:23], v[68:71], v[96:99], v[20:23]
  ds_read_b128 v[220:223], v56 offset:3584
  v_mfma_f32_16x16x32_bf16 v[24:27], v[68:71], v[100:103], v[24:27]
  ds_read_b64 v[128:129], v48 offset:3584
  v_mfma_f32_16x16x32_bf16 v[28:31], v[68:71], v[104:107], v[28:31]
  ds_read_b64 v[130:131], v48 offset:3592
  v_mfma_f32_16x16x32_bf16 v[32:35], v[68:71], v[108:111], v[32:35]
  ds_read_b64 v[132:133], v48 offset:3072
  v_mfma_f32_16x16x32_bf16 v[36:39], v[68:71], v[112:115], v[36:39]
  ds_read_b64 v[134:135], v48 offset:3080
  v_mfma_f32_16x16x32_bf16 v[40:43], v[68:71], v[116:119], v[40:43]
  ds_read_b64 v[136:137], v48 offset:2560
  v_mfma_f32_16x16x32_bf16 v[44:47], v[68:71], v[120:123], v[44:47]
  ds_read_b64 v[138:139], v48 offset:2568
  v_mfma_f32_16x16x32_bf16 v[24:27], v[72:75], v[96:99], v[24:27]
  ds_read_b64 v[140:141], v48 offset:2048
  v_mfma_f32_16x16x32_bf16 v[28:31], v[72:75], v[100:103], v[28:31]
  ds_read_b64 v[142:143], v48 offset:2056
  v_mfma_f32_16x16x32_bf16 v[32:35], v[72:75], v[104:107], v[32:35]
  ds_read_b64 v[144:145], v48 offset:1536
  v_mfma_f32_16x16x32_bf16 v[36:39], v[72:75], v[108:111], v[36:39]
  ds_read_b64 v[146:147], v48 offset:1544
  v_mfma_f32_16x16x32_bf16 v[40:43], v[72:75], v[112:115], v[40:43]
  ds_read_b64 v[148:149], v48 offset:1024
  v_mfma_f32_16x16x32_bf16 v[44:47], v[72:75], v[116:119], v[44:47]
  ds_read_b64 v[150:151], v48 offset:1032
  v_mfma_f32_16x16x32_bf16 v[28:31], v[76:79], v[96:99], v[28:31]
  ds_read_b64 v[152:153], v48 offset:512
  v_mfma_f32_16x16x32_bf16 v[32:35], v[76:79], v[100:103], v[32:35]
  ds_read_b64 v[154:155], v48 offset:520
  v_mfma_f32_16x16x32_bf16 v[36:39], v[76:79], v[104:107], v[36:39]
  ds_read_b64 v[156:157], v48 offset:0
  v_mfma_f32_16x16x32_bf16 v[40:43], v[76:79], v[108:111], v[40:43]
  ds_read_b64 v[158:159], v48 offset:8
  v_mfma_f32_16x16x32_bf16 v[44:47], v[76:79], v[112:115], v[44:47]
  v_mfma_f32_16x16x32_bf16 v[32:35], v[80:83], v[96:99], v[32:35]
  v_mfma_f32_16x16x32_bf16 v[36:39], v[80:83], v[100:103], v[36:39]
  v_mfma_f32_16x16x32_bf16 v[40:43], v[80:83], v[104:107], v[40:43]
  v_mfma_f32_16x16x32_bf16 v[44:47], v[80:83], v[108:111], v[44:47]
  v_mfma_f32_16x16x32_bf16 v[36:39], v[84:87], v[96:99], v[36:39]
  v_mfma_f32_16x16x32_bf16 v[40:43], v[84:87], v[100:103], v[40:43]
  v_mfma_f32_16x16x32_bf16 v[44:47], v[84:87], v[104:107], v[44:47]
  v_mfma_f32_16x16x32_bf16 v[40:43], v[88:91], v[96:99], v[40:43]
  v_mfma_f32_16x16x32_bf16 v[44:47], v[88:91], v[100:103], v[44:47]
  v_mfma_f32_16x16x32_bf16 v[44:47], v[92:95], v[96:99], v[44:47]
  s_waitcnt lgkmcnt(0)
  v_mfma_f32_16x16x32_bf16 v[16:19], v[128:131], v[192:195], v[16:19]
  v_mfma_f32_16x16x32_bf16 v[20:23], v[128:131], v[196:199], v[20:23]
  v_mfma_f32_16x16x32_bf16 v[24:27], v[128:131], v[200:203], v[24:27]
  v_mfma_f32_16x16x32_bf16 v[28:31], v[128:131], v[204:207], v[28:31]
  v_mfma_f32_16x16x32_bf16 v[32:35], v[128:131], v[208:211], v[32:35]
  v_mfma_f32_16x16x32_bf16 v[36:39], v[128:131], v[212:215], v[36:39]
  v_mfma_f32_16x16x32_bf16 v[40:43], v[128:131], v[216:219], v[40:43]
  v_mfma_f32_16x16x32_bf16 v[44:47], v[128:131], v[220:223], v[44:47]
  v_mfma_f32_16x16x32_bf16 v[20:23], v[132:135], v[192:195], v[20:23]
  v_mfma_f32_16x16x32_bf16 v[24:27], v[132:135], v[196:199], v[24:27]
  v_mfma_f32_16x16x32_bf16 v[28:31], v[132:135], v[200:203], v[28:31]
  v_mfma_f32_16x16x32_bf16 v[32:35], v[132:135], v[204:207], v[32:35]
  v_mfma_f32_16x16x32_bf16 v[36:39], v[132:135], v[208:211], v[36:39]
  v_mfma_f32_16x16x32_bf16 v[40:43], v[132:135], v[212:215], v[40:43]
  v_mfma_f32_16x16x32_bf16 v[44:47], v[132:135], v[216:219], v[44:47]
  v_mfma_f32_16x16x32_bf16 v[24:27], v[136:139], v[192:195], v[24:27]
  v_mfma_f32_16x16x32_bf16 v[28:31], v[136:139], v[196:199], v[28:31]
  v_mfma_f32_16x16x32_bf16 v[32:35], v[136:139], v[200:203], v[32:35]
  v_mfma_f32_16x16x32_bf16 v[36:39], v[136:139], v[204:207], v[36:39]
  v_mfma_f32_16x16x32_bf16 v[40:43], v[136:139], v[208:211], v[40:43]
  v_mfma_f32_16x16x32_bf16 v[44:47], v[136:139], v[212:215], v[44:47]
  v_mfma_f32_16x16x32_bf16 v[28:31], v[140:143], v[192:195], v[28:31]
  v_mfma_f32_16x16x32_bf16 v[32:35], v[140:143], v[196:199], v[32:35]
  v_mfma_f32_16x16x32_bf16 v[36:39], v[140:143], v[200:203], v[36:39]
  v_mfma_f32_16x16x32_bf16 v[40:43], v[140:143], v[204:207], v[40:43]
  v_mfma_f32_16x16x32_bf16 v[44:47], v[140:143], v[208:211], v[44:47]
  v_mfma_f32_16x16x32_bf16 v[32:35], v[144:147], v[192:195], v[32:35]
  v_mfma_f32_16x16x32_bf16 v[36:39], v[144:147], v[196:199], v[36:39]
  v_mfma_f32_16x16x32_bf16 v[40:43], v[144:147], v[200:203], v[40:43]
  v_mfma_f32_16x16x32_bf16 v[44:47], v[144:147], v[204:207], v[44:47]
  v_mfma_f32_16x16x32_bf16 v[36:39], v[148:151], v[192:195], v[36:39]
  v_mfma_f32_16x16x32_bf16 v[40:43], v[148:151], v[196:199], v[40:43]
  v_mfma_f32_16x16x32_bf16 v[44:47], v[148:151], v[200:203], v[44:47]
  v_mfma_f32_16x16x32_bf16 v[40:43], v[152:155], v[192:195], v[40:43]
  v_mfma_f32_16x16x32_bf16 v[44:47], v[152:155], v[196:199], v[44:47]
  v_mfma_f32_16x16x32_bf16 v[44:47], v[156:159], v[192:195], v[44:47]
  s_barrier
  s_lshl_b32 s26, s23, 12
  s_add_u32 s26, s26, 16384
  v_add_u32 v2, s26, v9
  s_xor_b32 s26, s23, 1
  s_lshl_b32 s26, s26, 12
  s_add_u32 s26, s26, 16384
  v_add_u32 v5, s26, v9
  v_and_b32 v3, 15, v0
  v_lshlrev_b32 v3, 5, v3
  v_lshrrev_b32 v4, 4, v0
  v_lshlrev_b32 v4, 3, v4
  v_add_u32 v3, v3, v4
  s_add_u32 s26, s28, 32768
  v_add_u32 v3, s26, v3
  v_add_u32 v4, s26, v9
  s_cmp_lg_u32 s25, 0
  s_cbranch_scc1 Lcx_34
  ds_write_b128 v2, v[32:35] offset:0
  ds_write_b128 v2, v[36:39] offset:1024
  ds_write_b128 v2, v[40:43] offset:2048
  ds_write_b128 v2, v[44:47] offset:3072
  s_waitcnt lgkmcnt(0)
  s_barrier
  ds_read_b128 v[64:67], v5 offset:0
  ds_read_b128 v[68:71], v5 offset:1024
  ds_read_b128 v[72:75], v5 offset:2048
  ds_read_b128 v[76:79], v5 offset:3072
  s_waitcnt lgkmcnt(0)
  v_add_f32 v16, v16, v64
  v_add_f32 v17, v17, v65
  v_add_f32 v18, v18, v66
  v_add_f32 v19, v19, v67
  v_add_f32 v20, v20, v68
  v_add_f32 v21, v21, v69
  v_add_f32 v22, v22, v70
  v_add_f32 v23, v23, v71
  v_add_f32 v24, v24, v72
  v_add_f32 v25, v25, v73
  v_add_f32 v26, v26, v74
  v_add_f32 v27, v27, v75
  v_add_f32 v28, v28, v76
  v_add_f32 v29, v29, v77
  v_add_f32 v30, v30, v78
  v_add_f32 v31, v31, v79
  v_cvt_pk_bf16_f32 v64, v16, v17
  v_cvt_pk_bf16_f32 v65, v18, v19
  v_cvt_pk_bf16_f32 v66, v20, v21
  v_cvt_pk_bf16_f32 v67, v22, v23
  v_cvt_pk_bf16_f32 v68, v24, v25
  v_cvt_pk_bf16_f32 v69, v26, v27
  v_cvt_pk_bf16_f32 v70, v28, v29
  v_cvt_pk_bf16_f32 v71, v30, v31
  s_branch Lcy_35
Lcx_34:
  ds_write_b128 v2, v[16:19] offset:0
  ds_write_b128 v2, v[20:23] offset:1024
  ds_write_b128 v2, v[24:27] offset:2048
  ds_write_b128 v2, v[28:31] offset:3072
  s_waitcnt lgkmcnt(0)
  s_barrier
  ds_read_b128 v[64:67], v5 offset:0
  ds_read_b128 v[68:71], v5 offset:1024
  ds_read_b128 v[72:75], v5 offset:2048
  ds_read_b128 v[76:79], v5 offset:3072
  s_waitcnt lgkmcnt(0)
  v_add_f32 v32, v32, v64
  v_add_f32 v33, v33, v65
  v_add_f32 v34, v34, v66
  v_add_f32 v35, v35, v67
  v_add_f32 v36, v36, v68
  v_add_f32 v37, v37, v69
  v_add_f32 v38, v38, v70
  v_add_f32 v39, v39, v71
  v_add_f32 v40, v40, v72
  v_add_f32 v41, v41, v73
  v_add_f32 v42, v42, v74
  v_add_f32 v43, v43, v75
  v_add_f32 v44, v44, v76
  v_add_f32 v45, v45, v77
  v_add_f32 v46, v46, v78
  v_add_f32 v47, v47, v79
  v_cvt_pk_bf16_f32 v64, v32, v33
  v_cvt_pk_bf16_f32 v65, v34, v35
  v_cvt_pk_bf16_f32 v66, v36, v37
  v_cvt_pk_bf16_f32 v67, v38, v39
  v_cvt_pk_bf16_f32 v68, v40, v41
  v_cvt_pk_bf16_f32 v69, v42, v43
  v_cvt_pk_bf16_f32 v70, v44, v45
  v_cvt_pk_bf16_f32 v71, v46, v47
Lcy_35:
  ds_write_b64 v3, v[64:65] offset:0
  ds_write_b64 v3, v[66:67] offset:512
  ds_write_b64 v3, v[68:69] offset:1024
  ds_write_b64 v3, v[70:71] offset:1536
  ds_read_b128 v[72:75], v4
  ds_read_b128 v[76:79], v4 offset:1024
  s_add_u32 s26, s62, 8388608
  s_add_u32 s27, s62, 8456192
  s_waitcnt lgkmcnt(0)
  buffer_store_dwordx4 v[72:75], v60, s[12:15], s26 offen sc1
  buffer_store_dwordx4 v[76:79], v60, s[12:15], s27 offen sc1
  v_lshrrev_b32 v7, 4, v0
  v_lshlrev_b32 v7, 3, v7
  v_bfe_u32 v8, v0, 2, 2
  v_add_u32 v7, v7, v8
  v_lshlrev_b32 v7, 7, v7
  v_and_b32 v8, 3, v0
  v_lshlrev_b32 v8, 3, v8
  v_add_u32 v7, v7, v8
  s_lshl_b32 s26, s23, 5
  v_add_u32 v7, s26, v7
  v_and_b32 v8, 15, v0
  s_lshl_b32 s26, s23, 4
  v_add_u32 v8, s26, v8
  v_lshlrev_b32 v14, 7, v8
  v_lshrrev_b32 v6, 4, v0
  v_lshlrev_b32 v6, 4, v6
  v_add_u32 v14, v14, v6
  v_mul_u32_u24 v50, 144, v8
  v_add_u32 v50, v50, v6
  v_add_u32 v50, 16384, v50
  v_lshrrev_b32 v51, 3, v0
  s_lshl_b32 s26, s23, 4
  v_add_u32 v51, s26, v51
  v_and_b32 v52, 7, v0
  v_lshlrev_b32 v52, 4, v52
  v_mul_u32_u24 v53, 144, v51
  v_add_u32 v53, v53, v52
  v_add_u32 v53, 16384, v53
  s_lshl_b32 s26, s21, 6
  v_add_u32 v51, s26, v51
  v_mul_u32_u24 v51, 1792, v51
  v_add_u32 v51, v51, v52
  s_lshl_b32 s34, s20, 7
  s_add_u32 s35, s34, 14336
  s_waitcnt vmcnt(2)
  v_lshlrev_b32 v192, 16, v224
  v_and_b32 v193, 0xffff0000, v224
  v_lshlrev_b32 v194, 16, v225
  v_and_b32 v195, 0xffff0000, v225
  v_lshlrev_b32 v196, 16, v226
  v_and_b32 v197, 0xffff0000, v226
  v_lshlrev_b32 v198, 16, v227
  v_and_b32 v199, 0xffff0000, v227
  v_lshlrev_b32 v200, 16, v228
  v_and_b32 v201, 0xffff0000, v228
  v_lshlrev_b32 v202, 16, v229
  v_and_b32 v203, 0xffff0000, v229
  v_lshlrev_b32 v204, 16, v230
  v_and_b32 v205, 0xffff0000, v230
  v_lshlrev_b32 v206, 16, v231
  v_and_b32 v207, 0xffff0000, v231
  s_waitcnt vmcnt(0)
  s_barrier
  s_cmp_lg_u32 s23, 0
  s_cbranch_scc1 Lafs_36
  s_lshl_b32 s26, s22, 7
  s_add_u32 s26, s26, 131072
  v_mov_b32 v10, s32
  v_mov_b32 v11, s32
  v_mov_b32 v12, s32
  v_mov_b32 v13, s32
  s_mov_b64 exec, 0xff
  buffer_store_dwordx4 v[10:13], v9, s[12:15], s26 offen sc1
  s_mov_b64 exec, -1
  s_nop 1
Lafs_36:
  v_lshlrev_b32 v208, 16, v184
  v_and_b32 v209, 0xffff0000, v184
  v_lshlrev_b32 v210, 16, v185
  v_and_b32 v211, 0xffff0000, v185
  v_lshlrev_b32 v212, 16, v186
  v_and_b32 v213, 0xffff0000, v186
  v_lshlrev_b32 v214, 16, v187
  v_and_b32 v215, 0xffff0000, v187
  v_lshlrev_b32 v216, 16, v188
  v_and_b32 v217, 0xffff0000, v188
  v_lshlrev_b32 v218, 16, v189
  v_and_b32 v219, 0xffff0000, v189
  v_lshlrev_b32 v220, 16, v190
  v_and_b32 v221, 0xffff0000, v190
  v_lshlrev_b32 v222, 16, v191
  v_and_b32 v223, 0xffff0000, v191
  v_mul_f32 v208, v208, v192
  v_mul_f32 v209, v209, v193
  v_mul_f32 v210, v210, v194
  v_mul_f32 v211, v211, v195
  v_mul_f32 v212, v212, v196
  v_mul_f32 v213, v213, v197
  v_mul_f32 v214, v214, v198
  v_mul_f32 v215, v215, v199
  v_mul_f32 v216, v216, v200
  v_mul_f32 v217, v217, v201
  v_mul_f32 v218, v218, v202
  v_mul_f32 v219, v219, v203
  v_mul_f32 v220, v220, v204
  v_mul_f32 v221, v221, v205
  v_mul_f32 v222, v222, v206
  v_mul_f32 v223, v223, v207
  s_cmp_lg_u32 s23, 0
  s_cbranch_scc1 Lafd_38
  s_lshl_b32 s26, s20, 12
  s_add_u32 s26, s26, 131072
  v_lshlrev_b32 v2, 7, v0
  s_mov_b32 s67, 0
  s_mov_b32 exec_hi, 0
Lafp_37:
  buffer_load_dword v3, v2, s[12:15], s26 offen sc1
  s_waitcnt vmcnt(0)
  v_cmp_ne_u32 vcc, s32, v3
  s_cbranch_vccz Lafd_38
  s_sleep 2
  s_add_u32 s67, s67, 1
  s_cmp_lt_u32 s67, 20000
  s_cbranch_scc1 Lafp_37
Lafd_38:
  s_mov_b64 exec, -1
  s_waitcnt lgkmcnt(0)
  s_barrier
  s_add_u32 m0, s28, 8192
  s_add_u32 s26, s63, 8388608
  buffer_load_dwordx4 v61, s[12:15], s26 offen sc1 lds
  s_add_u32 m0, s28, 9216
  s_add_u32 s26, s63, 8389632
  buffer_load_dwordx4 v61, s[12:15], s26 offen sc1 lds
  s_waitcnt vmcnt(0)
  s_barrier
  ds_read_b64_tr_b16 v[64:65], v7 offset:8192
  ds_read_b64_tr_b16 v[66:67], v7 offset:8704
  ds_read_b64_tr_b16 v[68:69], v7 offset:12288
  ds_read_b64_tr_b16 v[70:71], v7 offset:12800
  s_waitcnt lgkmcnt(2)
  v_lshlrev_b32 v96, 16, v64
  v_and_b32 v97, 0xffff0000, v64
  v_add_f32 v96, v96, v208
  v_add_f32 v97, v97, v209
  v_cvt_pk_bf16_f32 v104, v96, v97
  v_lshlrev_b32 v96, 16, v65
  v_and_b32 v97, 0xffff0000, v65
  v_add_f32 v96, v96, v210
  v_add_f32 v97, v97, v211
  v_cvt_pk_bf16_f32 v105, v96, v97
  v_lshlrev_b32 v96, 16, v66
  v_and_b32 v97, 0xffff0000, v66
  v_add_f32 v96, v96, v212
  v_add_f32 v97, v97, v213
  v_cvt_pk_bf16_f32 v106, v96, v97
  v_lshlrev_b32 v96, 16, v67
  v_and_b32 v97, 0xffff0000, v67
  v_add_f32 v96, v96, v214
  v_add_f32 v97, v97, v215
  v_cvt_pk_bf16_f32 v107, v96, v97
  ds_write_b128 v50, v[104:107] offset:0
  s_waitcnt lgkmcnt(1)
  v_lshlrev_b32 v96, 16, v68
  v_and_b32 v97, 0xffff0000, v68
  v_add_f32 v96, v96, v216
  v_add_f32 v97, v97, v217
  v_cvt_pk_bf16_f32 v108, v96, v97
  v_lshlrev_b32 v96, 16, v69
  v_and_b32 v97, 0xffff0000, v69
  v_add_f32 v96, v96, v218
  v_add_f32 v97, v97, v219
  v_cvt_pk_bf16_f32 v109, v96, v97
  v_lshlrev_b32 v96, 16, v70
  v_and_b32 v97, 0xffff0000, v70
  v_add_f32 v96, v96, v220
  v_add_f32 v97, v97, v221
  v_cvt_pk_bf16_f32 v110, v96, v97
  v_lshlrev_b32 v96, 16, v71
  v_and_b32 v97, 0xffff0000, v71
  v_add_f32 v96, v96, v222
  v_add_f32 v97, v97, v223
  v_cvt_pk_bf16_f32 v111, v96, v97
  ds_write_b128 v50, v[108:111] offset:64
  ds_read_b128 v[112:115], v53
  ds_read_b128 v[116:119], v53 offset:1152
  s_waitcnt lgkmcnt(1)
  buffer_store_dwordx4 v[112:115], v51, s[16:19], s34 offen sc1
  s_waitcnt lgkmcnt(0)
  buffer_store_dwordx4 v[116:119], v51, s[16:19], s35 offen sc1
  s_endpgm
L_exit:
  s_endpgm
.p2align 4
L_tab:
  .short 2560, 2560, 2560, 2560, 2556, 2556, 2556, 2556, 2556, 2556, 2556, 2552, 2552, 2552, 2552, 2552
  .short 2552, 2552, 2552, 2552, 2548, 2548, 2548, 2548, 2548, 2548, 2548, 2544, 2544, 2544, 2544, 2544
  .short 2544, 2544, 2544, 2544, 2540, 2540, 2540, 2540, 2540, 2540, 2540, 2536, 2536, 2536, 2536, 2536
  .short 2536, 2536, 2536, 2536, 2532, 2532, 2532, 2532, 2532, 2532, 2532, 2528, 2528, 2528, 2528, 2528
  .short 2528, 2528, 2528, 2528, 2524, 2524, 2524, 2524, 2524, 2524, 2524, 2520, 2520, 2520, 2520, 2520
  .short 2520, 2520, 2520, 2520, 2516, 2516, 2516, 2516, 2516, 2516, 2516, 2512, 2512, 2512, 2512, 2512
  .short 2512, 2512, 2512, 2512, 2508, 2508, 2508, 2508, 2508, 2508, 2508, 2504, 2504, 2504, 2504, 2504
  .short 2504, 2504, 2504, 2504, 2500, 2500, 2500, 2500, 2500, 2500, 2500, 2496, 2496, 2496, 2496, 2496
  .short 2496, 2496, 2496, 2496, 2492, 2492, 2492, 2492, 2492, 2492, 2492, 2488, 2488, 2488, 2488, 2488
  .short 2488, 2488, 2488, 2488, 2484, 2484, 2484, 2484, 2484, 2484, 2484, 2480, 2480, 2480, 2480, 2480
  .short 2480, 2480, 2480, 2480, 2476, 2476, 2476, 2476, 2476, 2476, 2476, 2472, 2472, 2472, 2472, 2472
  .short 2472, 2472, 2472, 2472, 2468, 2468, 2468, 2468, 2468, 2468, 2468, 2464, 2464, 2464, 2464, 2464
  .short 2464, 2464, 2464, 2464, 2460, 2460, 2460, 2460, 2460, 2460, 2460, 2456, 2456, 2456, 2456, 2456
  .short 2456, 2456, 2456, 2456, 2452, 2452, 2452, 2452, 2452, 2452, 2452, 2448, 2448, 2448, 2448, 2448
  .short 2448, 2448, 2448, 2448, 2444, 2444, 2444, 2444, 2444, 2444, 2444, 2440, 2440, 2440, 2440, 2440
  .short 2440, 2440, 2440, 2440, 2436, 2436, 2436, 2436, 2436, 2436, 2436, 2432, 2432, 2432, 2432, 2432
  .short 2432, 2432, 2432, 2432, 2428, 2428, 2428, 2428, 2428, 2428, 2428, 2424, 2424, 2424, 2424, 2424
  .short 2424, 2424, 2424, 2424, 2420, 2420, 2420, 2420, 2420, 2420, 2420, 2416, 2416, 2416, 2416, 2416
  .short 2416, 2416, 2416, 2416, 2412, 2412, 2412, 2412, 2412, 2412, 2412, 2408, 2408, 2408, 2408, 2408
  .short 2408, 2408, 2408, 2408, 2404, 2404, 2404, 2404, 2404, 2404, 2404, 2400, 2400, 2400, 2400, 2400
  .short 2400, 2400, 2400, 2400, 2396, 2396, 2396, 2396, 2396, 2396, 2396, 2392, 2392, 2392, 2392, 2392
  .short 2392, 2392, 2392, 2392, 2388, 2388, 2388, 2388, 2388, 2388, 2388, 2384, 2384, 2384, 2384, 2384
  .short 2384, 2384, 2384, 2384, 2380, 2380, 2380, 2380, 2380, 2380, 2380, 2376, 2376, 2376, 2376, 2376
  .short 2376, 2376, 2376, 2376, 2372, 2372, 2372, 2372, 2372, 2372, 2372, 2368, 2368, 2368, 2368, 2368
  .short 2368, 2368, 2368, 2368, 2364, 2364, 2364, 2364, 2364, 2364, 2364, 2360, 2360, 2360, 2360, 2360
  .short 2360, 2360, 2360, 2360, 2356, 2356, 2356, 2356, 2356, 2356, 2356, 2352, 2352, 2352, 2352, 2352
  .short 2352, 2352, 2352, 2352, 2348, 2348, 2348, 2348, 2348, 2348, 2348, 2344, 2344, 2344, 2344, 2344
  .short 2344, 2344, 2344, 2344, 2340, 2340, 2340, 2340, 2340, 2340, 2340, 2336, 2336, 2336, 2336, 2336
  .short 2336, 2336, 2336, 2336, 2332, 2332, 2332, 2332, 2332, 2332, 2332, 2328, 2328, 2328, 2328, 2328
  .short 2328, 2328, 2328, 2328, 2324, 2324, 2324, 2324, 2324, 2324, 2324, 2320, 2320, 2320, 2320, 2320
  .short 2320, 2320, 2320, 2320, 2316, 2316, 2316, 2316, 2316, 2316, 2316, 2312, 2312, 2312, 2312, 2312
  .short 2312, 2312, 2312, 2312, 2308, 2308, 2308, 2308, 2308, 2308, 2308, 2304, 2304, 2304, 2304, 2304
  .short 2304, 2304, 2304, 2304, 2300, 2300, 2300, 2300, 2300, 2300, 2300, 2296, 2296, 2296, 2296, 2296
  .short 2296, 2296, 2296, 2296, 2292, 2292, 2292, 2292, 2292, 2292, 2292, 2288, 2288, 2288, 2288, 2288
  .short 2288, 2288, 2288, 2288, 2284, 2284, 2284, 2284, 2284, 2284, 2284, 2280, 2280, 2280, 2280, 2280
  .short 2280, 2280, 2280, 2280, 2276, 2276, 2276, 2276, 2276, 2276, 2276, 2272, 2272, 2272, 2272, 2272
  .short 2272, 2272, 2272, 2272, 2268, 2268, 2268, 2268, 2268, 2268, 2268, 2264, 2264, 2264, 2264, 2264
  .short 2264, 2264, 2264, 2264, 2260, 2260, 2260, 2260, 2260, 2260, 2260, 2256, 2256, 2256, 2256, 2256
  .short 2256, 2256, 2256, 2256, 2252, 2252, 2252, 2252, 2252, 2252, 2252, 2248, 2248, 2248, 2248, 2248
  .short 2248, 2248, 2248, 2248, 2244, 2244, 2244, 2244, 2244, 2244, 2244, 2240, 2240, 2240, 2240, 2240
  .short 2240, 2240, 2240, 2240, 2236, 2236, 2236, 2236, 2236, 2236, 2236, 2232, 2232, 2232, 2232, 2232
  .short 2232, 2232, 2232, 2232, 2228, 2228, 2228, 2228, 2228, 2228, 2228, 2224, 2224, 2224, 2224, 2224
  .short 2224, 2224, 2224, 2224, 2220, 2220, 2220, 2220, 2220, 2220, 2220, 2216, 2216, 2216, 2216, 2216
  .short 2216, 2216, 2216, 2216, 2212, 2212, 2212, 2212, 2212, 2212, 2212, 2208, 2208, 2208, 2208, 2208
  .short 2208, 2208, 2208, 2208, 2204, 2204, 2204, 2204, 2204, 2204, 2204, 2200, 2200, 2200, 2200, 2200
  .short 2200, 2200, 2200, 2200, 2196, 2196, 2196, 2196, 2196, 2196, 2196, 2192, 2192, 2192, 2192, 2192
  .short 2192, 2192, 2192, 2192, 2188, 2188, 2188, 2188, 2188, 2188, 2188, 2184, 2184, 2184, 2184, 2184
  .short 2184, 2184, 2184, 2184, 2180, 2180, 2180, 2180, 2180, 2180, 2180, 2176, 2176, 2176, 2176, 2176
  .short 2176, 2176, 2176, 2176, 2172, 2172, 2172, 2172, 2172, 2172, 2172, 2168, 2168, 2168, 2168, 2168
  .short 2168, 2168, 2168, 2168, 2164, 2164, 2164, 2164, 2164, 2164, 2164, 2160, 2160, 2160, 2160, 2160
  .short 2160, 2160, 2160, 2160, 2156, 2156, 2156, 2156, 2156, 2156, 2156, 2152, 2152, 2152, 2152, 2152
  .short 2152, 2152, 2152, 2152, 2148, 2148, 2148, 2148, 2148, 2148, 2148, 2144, 2144, 2144, 2144, 2144
  .short 2144, 2144, 2144, 2144, 2140, 2140, 2140, 2140, 2140, 2140, 2140, 2136, 2136, 2136, 2136, 2136
  .short 2136, 2136, 2136, 2136, 2132, 2132, 2132, 2132, 2132, 2132, 2132, 2128, 2128, 2128, 2128, 2128
  .short 2128, 2128, 2128, 2128, 2124, 2124, 2124, 2124, 2124, 2124, 2124, 2120, 2120, 2120, 2120, 2120
  .short 2120, 2120, 2120, 2120, 2116, 2116, 2116, 2116, 2116, 2116, 2116, 2112, 2112, 2112, 2112, 2112
  .short 2112, 2112, 2112, 2112, 2108, 2108, 2108, 2108, 2108, 2108, 2108, 2104, 2104, 2104, 2104, 2104
  .short 2104, 2104, 2104, 2104, 2100, 2100, 2100, 2100, 2100, 2100, 2100, 2096, 2096, 2096, 2096, 2096
  .short 2096, 2096, 2096, 2096, 2092, 2092, 2092, 2092, 2092, 2092, 2092, 2088, 2088, 2088, 2088, 2088
  .short 2088, 2088, 2088, 2088, 2084, 2084, 2084, 2084, 2084, 2084, 2084, 2080, 2080, 2080, 2080, 2080
  .short 2080, 2080, 2080, 2080, 2076, 2076, 2076, 2076, 2076, 2076, 2076, 2072, 2072, 2072, 2072, 2072
  .short 2072, 2072, 2072, 2072, 2068, 2068, 2068, 2068, 2068, 2068, 2068, 2064, 2064, 2064, 2064, 2064
  .short 2064, 2064, 2064, 2064, 2060, 2060, 2060, 2060, 2060, 2060, 2060, 2056, 2056, 2056, 2056, 2056
  .short 2056, 2056, 2056, 2056, 2052, 2052, 2052, 2052, 2052, 2052, 2052, 2048, 2048, 2048, 2048, 2048
  .short 2048, 2048, 2044, 2044, 2044, 2040, 2040, 2040, 2040, 2040, 2036, 2036, 2036, 2032, 2032, 2032
  .short 2032, 2032, 2028, 2028, 2028, 2024, 2024, 2024, 2024, 2024, 2020, 2020, 2020, 2016, 2016, 2016
  .short 2016, 2016, 2012, 2012, 2012, 2008, 2008, 2008, 2008, 2008, 2004, 2004, 2004, 2000, 2000, 2000
  .short 2000, 2000, 1996, 1996, 1996, 1992, 1992, 1992, 1992, 1992, 1988, 1988, 1988, 1984, 1984, 1984
  .short 1984, 1984, 1980, 1980, 1980, 1976, 1976, 1976, 1976, 1976, 1972, 1972, 1972, 1968, 1968, 1968
  .short 1968, 1968, 1964, 1964, 1964, 1960, 1960, 1960, 1960, 1960, 1956, 1956, 1956, 1952, 1952, 1952
  .short 1952, 1952, 1948, 1948, 1948, 1944, 1944, 1944, 1944, 1944, 1940, 1940, 1940, 1936, 1936, 1936
  .short 1936, 1936, 1932, 1932, 1932, 1928, 1928, 1928, 1928, 1928, 1924, 1924, 1924, 1920, 1920, 1920
  .short 1920, 1920, 1916, 1916, 1916, 1912, 1912, 1912, 1912, 1912, 1908, 1908, 1908, 1904, 1904, 1904
  .short 1904, 1904, 1900, 1900, 1900, 1896, 1896, 1896, 1896, 1896, 1892, 1892, 1892, 1888, 1888, 1888
  .short 1888, 1888, 1884, 1884, 1884, 1880, 1880, 1880, 1880, 1880, 1876, 1876, 1876, 1872, 1872, 1872
  .short 1872, 1872, 1868, 1868, 1868, 1864, 1864, 1864, 1864, 1864, 1860, 1860, 1860, 1856, 1856, 1856
  .short 1856, 1856, 1852, 1852, 1852, 1848, 1848, 1848, 1848, 1848, 1844, 1844, 1844, 1840, 1840, 1840
  .short 1840, 1840, 1836, 1836, 1836, 1832, 1832, 1832, 1832, 1832, 1828, 1828, 1828, 1824, 1824, 1824
  .short 1824, 1824, 1820, 1820, 1820, 1816, 1816, 1816, 1816, 1816, 1812, 1812, 1812, 1808, 1808, 1808
  .short 1808, 1808, 1804, 1804, 1804, 1800, 1800, 1800, 1800, 1800, 1796, 1796, 1796, 1792, 1792, 1792
  .short 1792, 1792, 1788, 1788, 1788, 1784, 1784, 1784, 1784, 1784, 1780, 1780, 1780, 1776, 1776, 1776
  .short 1776, 1776, 1772, 1772, 1772, 1768, 1768, 1768, 1768, 1768, 1764, 1764, 1764, 1760, 1760, 1760
  .short 1760, 1760, 1756, 1756, 1756, 1752, 1752, 1752, 1752, 1752, 1748, 1748, 1748, 1744, 1744, 1744
  .short 1744, 1744, 1740, 1740, 1740, 1736, 1736, 1736, 1736, 1736, 1732, 1732, 1732, 1728, 1728, 1728
  .short 1728, 1728, 1724, 1724, 1724, 1720, 1720, 1720, 1720, 1720, 1716, 1716, 1716, 1712, 1712, 1712
  .short 1712, 1712, 1708, 1708, 1708, 1704, 1704, 1704, 1704, 1704, 1700, 1700, 1700, 1696, 1696, 1696
  .short 1696, 1696, 1692, 1692, 1692, 1688, 1688, 1688, 1688, 1688, 1684, 1684, 1684, 1680, 1680, 1680
  .short 1680, 1680, 1676, 1676, 1676, 1672, 1672, 1672, 1672, 1672, 1668, 1668, 1668, 1664, 1664, 1664
  .short 1664, 1664, 1660, 1660, 1660, 1656, 1656, 1656, 1656, 1656, 1652, 1652, 1652, 1648, 1648, 1648
  .short 1648, 1648, 1644, 1644, 1644, 1640, 1640, 1640, 1640, 1640, 1636, 1636, 1636, 1632, 1632, 1632
  .short 1632, 1632, 1628, 1628, 1628, 1624, 1624, 1624, 1624, 1624, 1620, 1620, 1620, 1616, 1616, 1616
  .short 1616, 1616, 1612, 1612, 1612, 1608, 1608, 1608, 1608, 1608, 1604, 1604, 1604, 1600, 1600, 1600
  .short 1600, 1600, 1596, 1596, 1596, 1592, 1592, 1592, 1592, 1592, 1588, 1588, 1588, 1584, 1584, 1584
  .short 1584, 1584, 1580, 1580, 1580, 1576, 1576, 1576, 1576, 1576, 1572, 1572, 1572, 1568, 1568, 1568
  .short 1568, 1568, 1564, 1564, 1564, 1560, 1560, 1560, 1560, 1560, 1556, 1556, 1556, 1552, 1552, 1552
  .short 1552, 1552, 1548, 1548, 1548, 1544, 1544, 1544, 1544, 1544, 1540, 1540, 1540, 1536, 1536, 1536
  .short 1536, 1532, 1528, 1528, 1528, 1524, 1520, 1520, 1520, 1516, 1512, 1512, 1512, 1508, 1504, 1504
  .short 1504, 1500, 1496, 1496, 1496, 1492, 1488, 1488, 1488, 1484, 1480, 1480, 1480, 1476, 1472, 1472
  .short 1472, 1468, 1464, 1464, 1464, 1460, 1456, 1456, 1456, 1452, 1448, 1448, 1448, 1444, 1440, 1440
  .short 1440, 1436, 1432, 1432, 1432, 1428, 1424, 1424, 1424, 1420, 1416, 1416, 1416, 1412, 1408, 1408
  .short 1408, 1404, 1400, 1400, 1400, 1396, 1392, 1392, 1392, 1388, 1384, 1384, 1384, 1380, 1376, 1376
  .short 1376, 1372, 1368, 1368, 1368, 1364, 1360, 1360, 1360, 1356, 1352, 1352, 1352, 1348, 1344, 1344
  .short 1344, 1340, 1336, 1336, 1336, 1332, 1328, 1328, 1328, 1324, 1320, 1320, 1320, 1316, 1312, 1312
  .short 1312, 1308, 1304, 1304, 1304, 1300, 1296, 1296, 1296, 1292, 1288, 1288, 1288, 1284, 1280, 1280
  .short 1280, 1276, 1272, 1272, 1272, 1268, 1264, 1264, 1264, 1260, 1256, 1256, 1256, 1252, 1248, 1248
  .short 1248, 1244, 1240, 1240, 1240, 1236, 1232, 1232, 1232, 1228, 1224, 1224, 1224, 1220, 1216, 1216
  .short 1216, 1212, 1208, 1208, 1208, 1204, 1200, 1200, 1200, 1196, 1192, 1192, 1192, 1188, 1184, 1184
  .short 1184, 1180, 1176, 1176, 1176, 1172, 1168, 1168, 1168, 1164, 1160, 1160, 1160, 1156, 1152, 1152
  .short 1152, 1148, 1144, 1144, 1144, 1140, 1136, 1136, 1136, 1132, 1128, 1128, 1128, 1124, 1120, 1120
  .short 1120, 1116, 1112, 1112, 1112, 1108, 1104, 1104, 1104, 1100, 1096, 1096, 1096, 1092, 1088, 1088
  .short 1088, 1084, 1080, 1080, 1080, 1076, 1072, 1072, 1072, 1068, 1064, 1064, 1064, 1060, 1056, 1056
  .short 1056, 1052, 1048, 1048, 1048, 1044, 1040, 1040, 1040, 1036, 1032, 1032, 1032, 1028, 1024, 1024
  .short 1020, 1016, 1012, 1008, 1004, 1000, 996, 992, 988, 984, 980, 976, 972, 968, 964, 960
  .short 956, 952, 948, 944, 940, 936, 932, 928, 924, 920, 916, 912, 908, 904, 900, 896
  .short 892, 888, 884, 880, 876, 872, 868, 864, 860, 856, 852, 848, 844, 840, 836, 832
  .short 828, 824, 820, 816, 812, 808, 804, 800, 796, 792, 788, 784, 780, 776, 772, 768
  .short 764, 760, 756, 752, 748, 744, 740, 736, 732, 728, 724, 720, 716, 712, 708, 704
  .short 700, 696, 692, 688, 684, 680, 676, 672, 668, 664, 660, 656, 652, 648, 644, 640
  .short 636, 632, 628, 624, 620, 616, 612, 608, 604, 600, 596, 592, 588, 584, 580, 576
  .short 572, 568, 564, 560, 556, 552, 548, 544, 540, 536, 532, 528, 524, 520, 516, 512
  .short 508, 504, 500, 496, 492, 488, 484, 480, 476, 472, 468, 464, 460, 456, 452, 448
  .short 444, 440, 436, 432, 428, 424, 420, 416, 412, 408, 404, 400, 396, 392, 388, 384
  .short 380, 376, 372, 368, 364, 360, 356, 352, 348, 344, 340, 336, 332, 328, 324, 320
  .short 316, 312, 308, 304, 300, 296, 292, 288, 284, 280, 276, 272, 268, 264, 260, 256
  .short 252, 248, 244, 240, 236, 232, 228, 224, 220, 216, 212, 208, 204, 200, 196, 192
  .short 188, 184, 180, 176, 172, 168, 164, 160, 156, 152, 148, 144, 140, 136, 132, 128
  .short 124, 120, 116, 112, 108, 104, 100, 96, 92, 88, 84, 80, 76, 72, 68, 64
  .short 60, 56, 52, 48, 44, 40, 36, 32, 28, 24, 20, 16, 12, 8, 4, 0
  .short 2556, 2556, 2556, 0, 2552, 2552, 2552, 0, 2548, 2548, 2548, 0, 2544, 2544, 2544, 0
  .short 2540, 2540, 2540, 0, 2536, 2536, 2536, 0, 2532, 2532, 2532, 0, 2528, 2528, 2528, 0
  .short 2524, 2524, 2524, 0, 2520, 2520, 2520, 0, 2516, 2516, 2516, 0, 2512, 2512, 2512, 0
  .short 2508, 2508, 2508, 0, 2504, 2504, 2504, 0, 2500, 2500, 2500, 0, 2496, 2496, 2496, 0
  .short 2492, 2492, 2492, 0, 2488, 2488, 2488, 0, 2484, 2484, 2484, 0, 2480, 2480, 2480, 0
  .short 2476, 2476, 2476, 0, 2472, 2472, 2472, 0, 2468, 2468, 2468, 0, 2464, 2464, 2464, 0
  .short 2460, 2460, 2460, 0, 2456, 2456, 2456, 0, 2452, 2452, 2452, 0, 2448, 2448, 2448, 0
  .short 2444, 2444, 2444, 0, 2440, 2440, 2440, 0, 2436, 2436, 2436, 0, 2432, 2432, 2432, 0
  .short 2428, 2428, 2428, 0, 2424, 2424, 2424, 0, 2420, 2420, 2420, 0, 2416, 2416, 2416, 0
  .short 2412, 2412, 2412, 0, 2408, 2408, 2408, 0, 2404, 2404, 2404, 0, 2400, 2400, 2400, 0
  .short 2396, 2396, 2396, 0, 2392, 2392, 2392, 0, 2388, 2388, 2388, 0, 2384, 2384, 2384, 0
  .short 2380, 2380, 2380, 0, 2376, 2376, 2376, 0, 2372, 2372, 2372, 0, 2368, 2368, 2368, 0
  .short 2364, 2364, 2364, 0, 2360, 2360, 2360, 0, 2356, 2356, 2356, 0, 2352, 2352, 2352, 0
  .short 2348, 2348, 2348, 0, 2344, 2344, 2344, 0, 2340, 2340, 2340, 0, 2336, 2336, 2336, 0
  .short 2332, 2332, 2332, 0, 2328, 2328, 2328, 0, 2324, 2324, 2324, 0, 2320, 2320, 2320, 0
  .short 2316, 2316, 2316, 0, 2312, 2312, 2312, 0, 2308, 2308, 2308, 0, 2304, 2304, 2304, 0
  .short 2300, 2300, 2300, 0, 2296, 2296, 2296, 0, 2292, 2292, 2292, 0, 2288, 2288, 2288, 0
  .short 2284, 2284, 2284, 0, 2280, 2280, 2280, 0, 2276, 2276, 2276, 0, 2272, 2272, 2272, 0
  .short 2268, 2268, 2268, 0, 2264, 2264, 2264, 0, 2260, 2260, 2260, 0, 2256, 2256, 2256, 0
  .short 2252, 2252, 2252, 0, 2248, 2248, 2248, 0, 2244, 2244, 2244, 0, 2240, 2240, 2240, 0
  .short 2236, 2236, 2236, 0, 2232, 2232, 2232, 0, 2228, 2228, 2228, 0, 2224, 2224, 2224, 0
  .short 2220, 2220, 2220, 0, 2216, 2216, 2216, 0, 2212, 2212, 2212, 0, 2208, 2208, 2208, 0
  .short 2204, 2204, 2204, 0, 2200, 2200, 2200, 0, 2196, 2196, 2196, 0, 2192, 2192, 2192, 0
  .short 2188, 2188, 2188, 0, 2184, 2184, 2184, 0, 2180, 2180, 2180, 0, 2176, 2176, 2176, 0
  .short 2172, 2172, 2172, 0, 2168, 2168, 2168, 0, 2164, 2164, 2164, 0, 2160, 2160, 2160, 0
  .short 2156, 2156, 2156, 0, 2152, 2152, 2152, 0, 2148, 2148, 2148, 0, 2144, 2144, 2144, 0
  .short 2140, 2140, 2140, 0, 2136, 2136, 2136, 0, 2132, 2132, 2132, 0, 2128, 2128, 2128, 0
  .short 2124, 2124, 2124, 0, 2120, 2120, 2120, 0, 2116, 2116, 2116, 0, 2112, 2112, 2112, 0
  .short 2108, 2108, 2108, 0, 2104, 2104, 2104, 0, 2100, 2100, 2100, 0, 2096, 2096, 2096, 0
  .short 2092, 2092, 2092, 0, 2088, 2088, 2088, 0, 2084, 2084, 2084, 0, 2080, 2080, 2080, 0
  .short 2076, 2076, 2076, 0, 2072, 2072, 2072, 0, 2068, 2068, 2068, 0, 2064, 2064, 2064, 0
  .short 2060, 2060, 2060, 0, 2056, 2056, 2056, 0, 2052, 2052, 2052, 0, 2048, 2048, 2044, 0
  .short 2040, 2040, 2036, 0, 2032, 2032, 2028, 0, 2024, 2024, 2020, 0, 2016, 2016, 2012, 0
  .short 2008, 2008, 2004, 0, 2000, 2000, 1996, 0, 1992, 1992, 1988, 0, 1984, 1984, 1980, 0
  .short 1976, 1976, 1972, 0, 1968, 1968, 1964, 0, 1960, 1960, 1956, 0, 1952, 1952, 1948, 0
  .short 1944, 1944, 1940, 0, 1936, 1936, 1932, 0, 1928, 1928, 1924, 0, 1920, 1920, 1916, 0
  .short 1912, 1912, 1908, 0, 1904, 1904, 1900, 0, 1896, 1896, 1892, 0, 1888, 1888, 1884, 0
  .short 1880, 1880, 1876, 0, 1872, 1872, 1868, 0, 1864, 1864, 1860, 0, 1856, 1856, 1852, 0
  .short 1848, 1848, 1844, 0, 1840, 1840, 1836, 0, 1832, 1832, 1828, 0, 1824, 1824, 1820, 0
  .short 1816, 1816, 1812, 0, 1808, 1808, 1804, 0, 1800, 1800, 1796, 0, 1792, 1792, 1788, 0
  .short 1784, 1784, 1780, 0, 1776, 1776, 1772, 0, 1768, 1768, 1764, 0, 1760, 1760, 1756, 0
  .short 1752, 1752, 1748, 0, 1744, 1744, 1740, 0, 1736, 1736, 1732, 0, 1728, 1728, 1724, 0
  .short 1720, 1720, 1716, 0, 1712, 1712, 1708, 0, 1704, 1704, 1700, 0, 1696, 1696, 1692, 0
  .short 1688, 1688, 1684, 0, 1680, 1680, 1676, 0, 1672, 1672, 1668, 0, 1664, 1664, 1660, 0
  .short 1656, 1656, 1652, 0, 1648, 1648, 1644, 0, 1640, 1640, 1636, 0, 1632, 1632, 1628, 0
  .short 1624, 1624, 1620, 0, 1616, 1616, 1612, 0, 1608, 1608, 1604, 0, 1600, 1600, 1596, 0
  .short 1592, 1592, 1588, 0, 1584, 1584, 1580, 0, 1576, 1576, 1572, 0, 1568, 1568, 1564, 0
  .short 1560, 1560, 1556, 0, 1552, 1552, 1548, 0, 1544, 1544, 1540, 0, 1536, 1532, 1528, 0
  .short 1520, 1516, 1512, 0, 1504, 1500, 1496, 0, 1488, 1484, 1480, 0, 1472, 1468, 1464, 0
  .short 1456, 1452, 1448, 0, 1440, 1436, 1432, 0, 1424, 1420, 1416, 0, 1408, 1404, 1400, 0
  .short 1392, 1388, 1384, 0, 1376, 1372, 1368, 0, 1360, 1356, 1352, 0, 1344, 1340, 1336, 0
  .short 1328, 1324, 1320, 0, 1312, 1308, 1304, 0, 1296, 1292, 1288, 0, 1280, 1276, 1272, 0
  .short 1264, 1260, 1256, 0, 1248, 1244, 1240, 0, 1232, 1228, 1224, 0, 1216, 1212, 1208, 0
  .short 1200, 1196, 1192, 0, 1184, 1180, 1176, 0, 1168, 1164, 1160, 0, 1152, 1148, 1144, 0
  .short 1136, 1132, 1128, 0, 1120, 1116, 1112, 0, 1104, 1100, 1096, 0, 1088, 1084, 1080, 0
  .short 1072, 1068, 1064, 0, 1056, 1052, 1048, 0, 1040, 1036, 1032, 0, 1020, 1016, 1012, 0
  .short 988, 984, 980, 0, 956, 952, 948, 0, 924, 920, 916, 0, 892, 888, 884, 0
  .short 860, 856, 852, 0, 828, 824, 820, 0, 796, 792, 788, 0, 764, 760, 756, 0
  .short 732, 728, 724, 0, 700, 696, 692, 0, 668, 664, 660, 0, 636, 632, 628, 0
  .short 604, 600, 596, 0, 572, 568, 564, 0, 540, 536, 532, 0, 508, 504, 500, 0
  .short 476, 472, 468, 0, 444, 440, 436, 0, 412, 408, 404, 0, 380, 376, 372, 0
  .short 348, 344, 340, 0, 316, 312, 308, 0, 284, 280, 276, 0, 252, 248, 244, 0
  .short 220, 216, 212, 0, 188, 184, 180, 0, 156, 152, 148, 0, 124, 120, 116, 0
  .short 92, 88, 84, 0, 60, 56, 52, 0, 28, 24, 20, 0, 2600, 2600, 2600, 0
L_end:
.section .rodata,"a"
.p2align 6
.amdhsa_kernel concat_heads__ssm_conv_s4__linear_kernel_hedgehog__prompt_kernel
  .amdhsa_next_free_vgpr 256
  .amdhsa_next_free_sgpr 102
  .amdhsa_accum_offset 256
  .amdhsa_group_segment_fixed_size 0
  .amdhsa_kernarg_size 128
  .amdhsa_user_sgpr_count 2
  .amdhsa_user_sgpr_kernarg_segment_ptr 1
  .amdhsa_system_sgpr_workgroup_id_x 1
.end_amdhsa_kernel
```
